```python
import torch

def _softmax(x, axis=-1):
    return torch.softmax(x, dim=axis)
def _gelu(x):
    return torch.nn.functional.gelu(x, approximate="tanh")
def _silu(x):
    return torch.nn.functional.silu(x)
def _sigmoid(x):
    return torch.sigmoid(x)
def _layernorm(x, axis=-1, eps=1e-5):
    m = x.mean(dim=axis, keepdim=True)
    v = x.var(dim=axis, keepdim=True, unbiased=False)
    return (x - m) / torch.sqrt(v + eps)
def _scatter_add(tgt, idx, src, axis=0):
    return tgt.clone().index_add_(axis, idx, src)
def _segment_sum(src, seg, n):
    out = torch.zeros((n,) + src.shape[1:], dtype=src.dtype)
    return out.index_add_(0, seg, src)
def _pad(x, pw):
    flat = tuple(v for pair in reversed(pw) for v in pair)
    return torch.nn.functional.pad(x, flat)

kernel_name = 'sequential_preLN__mha_block__moe_arch_mod__prompt'

def setup_inputs():

    _w = (lambda a: (lambda t: t.to(torch.bfloat16) if t.is_floating_point() else t)(torch.as_tensor(a)))
    def _A_setup():
        B, S, D, H = 1, 2048, 448, 16
        return {
            "x": _w((lambda *s: torch.randn(*s, dtype=torch.bfloat16) * 0.05)(B, S, D)),
            "wqkv": _w((lambda *s: torch.randn(*s, dtype=torch.bfloat16) * 0.05)(D, 3 * D)),
            "wo": _w((lambda *s: torch.randn(*s, dtype=torch.bfloat16) * 0.05)(D, D)),
        }
    _A_in = _A_setup()

    def _B_setup():
        B, S, D, F, C = 1, 2048, 448, 1792, 8
        return {
            "x": _w((lambda *s: torch.randn(*s, dtype=torch.bfloat16) * 0.05)(B, S, D)),
            "w_r": _w((lambda *s: torch.randn(*s, dtype=torch.bfloat16) * 0.05)(D)),
            "w_gate": _w((lambda *s: torch.randn(*s, dtype=torch.bfloat16) * 0.05)(D, F)),
            "w_up": _w((lambda *s: torch.randn(*s, dtype=torch.bfloat16) * 0.05)(D, F)),
            "w_down": _w((lambda *s: torch.randn(*s, dtype=torch.bfloat16) * 0.05)(F, D)),
        }
    _B_in = _B_setup()

    return {
        "A_x": _A_in["x"],
        "A_wqkv": _A_in["wqkv"],
        "A_wo": _A_in["wo"],
        "B_x": _B_in["x"],
        "B_w_r": _B_in["w_r"],
        "B_w_gate": _B_in["w_gate"],
        "B_w_up": _B_in["w_up"],
        "B_w_down": _B_in["w_down"],
    }

def reference(A_x, A_wqkv, A_wo, B_x, B_w_r, B_w_gate, B_w_up, B_w_down):
    def _A_ref(x, wqkv, wo):
        B, S, D = x.shape
        H = 16
        Dh = D // H
        qkv = (lambda x, *d: x.permute(*d))((x @ wqkv).reshape(B, S, 3, H, Dh), 2, 0, 3, 1, 4)
        q, k, v = qkv[0], qkv[1], qkv[2]
        scores = torch.einsum("bhqd,bhkd->bhqk", q, k) * (Dh ** -0.5)
        p = _softmax(scores, axis=-1)
        o = torch.einsum("bhqk,bhkd->bhqd", p, v)
        return (lambda x, *d: x.permute(*d))(o, 0, 2, 1, 3).reshape(B, S, D) @ wo

    def _B_ref(x, w_r, w_gate, w_up, w_down):
        B, S, D = x.shape
        C = 8
        r = x @ w_r
        idx = torch.argsort(-r, axis=-1)[:, :C]
        idx_e = (lambda x, n, axis: torch.repeat_interleave(x, n, dim=axis))(idx.reshape(B, C, 1), D, axis=2)
        x_sel = (lambda x, i, axis: torch.take_along_dim(x, i, dim=axis))(x, idx_e, axis=1)
        g = _silu(x_sel @ w_gate)
        u = x_sel @ w_up
        y = (g * u) @ w_down
        r_sel = _sigmoid((lambda x, i, axis: torch.take_along_dim(x, i, dim=axis))(r, idx, axis=1))
        y = y * r_sel.reshape(B, C, 1)
        b_off = (torch.arange(B) * S).reshape(B, 1)
        flat_idx = (idx + b_off).reshape(B * C)
        zero = (x * 0.0).reshape(B * S, D)
        upd = _scatter_add(zero, flat_idx, y.reshape(B * C, D), axis=0)
        return x + upd.reshape(B, S, D)

    x = A_x
    h = x + _A_ref(_layernorm(x, axis=-1), A_wqkv, A_wo)
    h2 = h + _B_ref(_layernorm(h, axis=-1), B_w_r, B_w_gate, B_w_up, B_w_down)
    return h2
```

```asm
; @launch grid=(256,1,1) block=(320,1,1) lds=163840
.amdgcn_target "amdgcn-amd-amdhsa--gfx950"
.text
.globl sequential_preLN__mha_block__moe_arch_mod__prompt_kernel
.p2align 12
.p2align 8
.type sequential_preLN__mha_block__moe_arch_mod__prompt_kernel,@function
sequential_preLN__mha_block__moe_arch_mod__prompt_kernel:
  s_cmp_ge_u32 s2, 256
  s_cbranch_scc1 L_end
  s_load_dwordx16 s[64:79], s[0:1], 0
  s_load_dwordx4 s[80:83], s[0:1], 64
  s_load_dwordx2 s[84:85], s[0:1], 80
  v_lshrrev_b32 v1, 6, v0
  v_and_b32 v0, 63, v0
  s_and_b32 s51, s2, 7
  s_lshr_b32 s50, s2, 3
  v_readfirstlane_b32 s44, v1
  s_lshr_b32 s94, s51, 1
  s_and_b32 s95, s51, 1
  s_and_b32 s48, s50, 3
  s_lshr_b32 s63, s50, 2
  s_lshl_b32 s46, s95, 3
  s_add_u32 s46, s46, s63
  s_lshl_b32 s45, s94, 2
  s_add_u32 s45, s45, s48
  s_cmp_eq_u32 s44, 4
  s_cbranch_scc1 L_helper
  v_lshrrev_b32 v22, 3, v0
  v_mul_u32_u24 v22, 896, v22
  v_lshrrev_b32 v23, 4, v0
  v_and_b32 v24, 7, v0
  v_xor_b32 v23, v23, v24
  v_lshl_add_u32 v1, v23, 4, v22
  v_xor_b32 v23, 4, v23
  v_lshl_add_u32 v2, v23, 4, v22
  v_add_u32 v2, 6144, v2
  v_add_u32 v3, 12288, v1
  v_add_u32 v4, 12288, v2
  v_lshrrev_b32 v22, 2, v0
  v_mul_u32_u24 v22, 2688, v22
  v_and_b32 v23, 3, v0
  v_lshlrev_b32 v23, 4, v23
  v_min_u32 v23, 40, v23
  v_add_u32 v5, v23, v22
  s_lshl_b32 s59, s46, 2
  s_add_u32 s59, s59, s44
  s_mul_i32 s59, s59, 28672
  s_lshl_b32 s92, s44, 14
  s_add_u32 s92, s92, 86016
  s_mul_i32 s91, s44, 43008
  s_mul_i32 s93, s45, 56
  s_add_u32 s91, s91, s93
  s_add_u32 s91, s91, 896
  s_mul_i32 s93, s44, 21504
  s_mov_b32 s10, 1835008
  s_mov_b32 s11, 0x20000
  s_mov_b32 s14, 1204224
  s_mov_b32 s15, 0x20000
  s_add_u32 s52, s48, s63
  s_and_b32 s52, s52, 1
  s_mul_i32 s52, s52, 1
  s_add_u32 s53, s52, 1
  s_cmp_eq_u32 s53, 7
  s_cselect_b32 s53, 0, s53
  s_waitcnt lgkmcnt(0)
  s_mov_b32 s8, s64
  s_mov_b32 s9, s65
  s_mov_b32 s12, s66
  s_mov_b32 s13, s67
  s_lshl_b32 s61, s52, 7
  s_add_u32 m0, s92, 0
  s_add_u32 s61, s61, s59
  buffer_load_dwordx4 v1, s[8:11], s61 offen lds
  buffer_load_dwordx4 v2, s[8:11], s61 offen offset:1024 lds
  buffer_load_dwordx4 v3, s[8:11], s61 offen offset:2048 lds
  buffer_load_dwordx4 v4, s[8:11], s61 offen offset:3072 lds
  s_mul_i32 s52, s52, 172032
  s_add_u32 m0, s93, 0
  s_add_u32 s52, s52, s91
  s_sub_u32 s62, s52, 128
  buffer_load_dwordx4 v5, s[12:15], s52 offen lds
  buffer_load_dwordx4 v5, s[12:15], s62 offen offset:1024 lds
  s_add_u32 s54, s53, 1
  s_cmp_eq_u32 s54, 7
  s_cselect_b32 s54, 0, s54
  s_add_u32 s55, s54, 1
  s_cmp_eq_u32 s55, 7
  s_cselect_b32 s55, 0, s55
  s_add_u32 s56, s55, 1
  s_cmp_eq_u32 s56, 7
  s_cselect_b32 s56, 0, s56
  s_add_u32 s57, s56, 1
  s_cmp_eq_u32 s57, 7
  s_cselect_b32 s57, 0, s57
  s_add_u32 s58, s57, 1
  s_cmp_eq_u32 s58, 7
  s_cselect_b32 s58, 0, s58
  s_mov_b32 s60, 0x3f803f80
  v_and_b32 v22, 31, v0
  v_lshrrev_b32 v23, 5, v0
  v_lshrrev_b32 v24, 1, v22
  v_and_b32 v24, 7, v24
  v_xor_b32 v24, v24, v23
  v_lshlrev_b32 v22, 7, v22
  v_add_u32 v22, s92, v22
  v_lshl_add_u32 v22, v24, 4, v22
  v_lshrrev_b32 v25, 2, v0
  v_and_b32 v25, 3, v25
  v_lshl_add_u32 v25, v23, 3, v25
  v_lshlrev_b32 v25, 6, v25
  v_lshrrev_b32 v26, 4, v0
  v_and_b32 v26, 1, v26
  v_lshl_add_u32 v25, v26, 5, v25
  v_lshrrev_b32 v27, 1, v0
  v_and_b32 v27, v27, v26
  v_and_b32 v26, 3, v0
  v_xor_b32 v26, v26, v27
  v_lshl_add_u32 v25, v26, 3, v25
  s_add_u32 s61, s44, 0
  s_and_b32 s61, s61, 3
  s_lshl_b32 s62, s61, 5
  s_mul_i32 s63, s61, 21504
  v_xor_b32 v6, s62, v22
  v_add_u32 v10, s63, v25
  s_add_u32 s61, s44, 1
  s_and_b32 s61, s61, 3
  s_lshl_b32 s62, s61, 5
  s_mul_i32 s63, s61, 21504
  v_xor_b32 v7, s62, v22
  v_add_u32 v11, s63, v25
  s_add_u32 s61, s44, 2
  s_and_b32 s61, s61, 3
  s_lshl_b32 s62, s61, 5
  s_mul_i32 s63, s61, 21504
  v_xor_b32 v8, s62, v22
  v_add_u32 v12, s63, v25
  s_add_u32 s61, s44, 3
  s_and_b32 s61, s61, 3
  s_lshl_b32 s62, s61, 5
  s_mul_i32 s63, s61, 21504
  v_xor_b32 v9, s62, v22
  v_add_u32 v13, s63, v25
  v_mov_b32 v14, 0
  v_mov_b32 v15, 0
  v_mov_b32 v16, 0
  v_mov_b32 v17, 0
  v_mov_b32 v18, 0
  v_mov_b32 v19, 0
  v_mov_b32 v31, 0
  s_lshl_b32 s61, s53, 7
  s_add_u32 m0, s92, 4096
  s_add_u32 s61, s61, s59
  buffer_load_dwordx4 v1, s[8:11], s61 offen lds
  buffer_load_dwordx4 v2, s[8:11], s61 offen offset:1024 lds
  buffer_load_dwordx4 v3, s[8:11], s61 offen offset:2048 lds
  buffer_load_dwordx4 v4, s[8:11], s61 offen offset:3072 lds
  s_waitcnt vmcnt(6)
  ds_read_b128 v[128:131], v6 offset:0
  ds_read_b128 v[132:135], v7 offset:0
  ds_read_b128 v[136:139], v8 offset:0
  ds_read_b128 v[140:143], v9 offset:0
  s_mul_i32 s53, s53, 172032
  s_add_u32 m0, s93, 3072
  s_add_u32 s53, s53, s91
  s_sub_u32 s62, s53, 128
  buffer_load_dwordx4 v5, s[12:15], s53 offen lds
  buffer_load_dwordx4 v5, s[12:15], s62 offen offset:1024 lds
  s_lshl_b32 s61, s54, 7
  s_add_u32 m0, s92, 8192
  s_add_u32 s61, s61, s59
  buffer_load_dwordx4 v1, s[8:11], s61 offen lds
  buffer_load_dwordx4 v2, s[8:11], s61 offen offset:1024 lds
  buffer_load_dwordx4 v3, s[8:11], s61 offen offset:2048 lds
  buffer_load_dwordx4 v4, s[8:11], s61 offen offset:3072 lds
  s_waitcnt lgkmcnt(0)
  v_dot2c_f32_bf16 v14, s60, v128
  v_dot2c_f32_bf16 v16, v128, v128
  v_dot2c_f32_bf16 v15, s60, v129
  v_dot2c_f32_bf16 v17, v129, v129
  v_dot2c_f32_bf16 v14, s60, v130
  v_dot2c_f32_bf16 v16, v130, v130
  v_dot2c_f32_bf16 v15, s60, v131
  v_dot2c_f32_bf16 v17, v131, v131
  v_dot2c_f32_bf16 v14, s60, v132
  v_dot2c_f32_bf16 v16, v132, v132
  v_dot2c_f32_bf16 v15, s60, v133
  v_dot2c_f32_bf16 v17, v133, v133
  v_dot2c_f32_bf16 v14, s60, v134
  v_dot2c_f32_bf16 v16, v134, v134
  v_dot2c_f32_bf16 v15, s60, v135
  v_dot2c_f32_bf16 v17, v135, v135
  v_dot2c_f32_bf16 v14, s60, v136
  v_dot2c_f32_bf16 v16, v136, v136
  v_dot2c_f32_bf16 v15, s60, v137
  v_dot2c_f32_bf16 v17, v137, v137
  v_dot2c_f32_bf16 v14, s60, v138
  v_dot2c_f32_bf16 v16, v138, v138
  v_dot2c_f32_bf16 v15, s60, v139
  v_dot2c_f32_bf16 v17, v139, v139
  v_dot2c_f32_bf16 v14, s60, v140
  v_dot2c_f32_bf16 v16, v140, v140
  v_dot2c_f32_bf16 v15, s60, v141
  v_dot2c_f32_bf16 v17, v141, v141
  v_dot2c_f32_bf16 v14, s60, v142
  v_dot2c_f32_bf16 v16, v142, v142
  v_dot2c_f32_bf16 v15, s60, v143
  v_dot2c_f32_bf16 v17, v143, v143
  s_waitcnt vmcnt(6)
  s_barrier
  ds_read_b64_tr_b16 v[80:81], v10 offset:0
  ds_read_b64_tr_b16 v[82:83], v10 offset:256
  ds_read_b64_tr_b16 v[84:85], v10 offset:1024
  ds_read_b64_tr_b16 v[86:87], v10 offset:1280
  ds_read_b128 v[144:147], v6 offset:4096
  ds_read_b128 v[148:151], v7 offset:4096
  ds_read_b128 v[152:155], v8 offset:4096
  ds_read_b128 v[156:159], v9 offset:4096
  ds_read_b64_tr_b16 v[88:89], v11 offset:0
  ds_read_b64_tr_b16 v[90:91], v11 offset:256
  ds_read_b64_tr_b16 v[92:93], v11 offset:1024
  ds_read_b64_tr_b16 v[94:95], v11 offset:1280
  ds_read_b64_tr_b16 v[240:241], v12 offset:0
  ds_read_b64_tr_b16 v[242:243], v12 offset:256
  ds_read_b64_tr_b16 v[244:245], v12 offset:1024
  ds_read_b64_tr_b16 v[246:247], v12 offset:1280
  ds_read_b64_tr_b16 v[248:249], v13 offset:0
  ds_read_b64_tr_b16 v[250:251], v13 offset:256
  ds_read_b64_tr_b16 v[252:253], v13 offset:1024
  ds_read_b64_tr_b16 v[254:255], v13 offset:1280
  s_mul_i32 s54, s54, 172032
  s_add_u32 m0, s93, 6144
  s_add_u32 s54, s54, s91
  s_sub_u32 s62, s54, 128
  buffer_load_dwordx4 v5, s[12:15], s54 offen lds
  buffer_load_dwordx4 v5, s[12:15], s62 offen offset:1024 lds
  s_lshl_b32 s61, s55, 7
  s_add_u32 m0, s92, 12288
  s_add_u32 s61, s61, s59
  buffer_load_dwordx4 v1, s[8:11], s61 offen lds
  buffer_load_dwordx4 v2, s[8:11], s61 offen offset:1024 lds
  buffer_load_dwordx4 v3, s[8:11], s61 offen offset:2048 lds
  buffer_load_dwordx4 v4, s[8:11], s61 offen offset:3072 lds
  global_load_dword v30, v31, s[84:85] sc1
  s_waitcnt lgkmcnt(12)
  v_dot2c_f32_bf16 v18, s60, v80
  v_dot2c_f32_bf16 v19, s60, v84
  v_dot2c_f32_bf16 v18, s60, v81
  v_dot2c_f32_bf16 v19, s60, v85
  v_dot2c_f32_bf16 v18, s60, v82
  v_dot2c_f32_bf16 v19, s60, v86
  v_dot2c_f32_bf16 v18, s60, v83
  v_dot2c_f32_bf16 v19, s60, v87
  v_dot2c_f32_bf16 v14, s60, v144
  v_dot2c_f32_bf16 v16, v144, v144
  v_dot2c_f32_bf16 v15, s60, v145
  v_dot2c_f32_bf16 v17, v145, v145
  v_dot2c_f32_bf16 v14, s60, v146
  v_dot2c_f32_bf16 v16, v146, v146
  v_dot2c_f32_bf16 v15, s60, v147
  v_dot2c_f32_bf16 v17, v147, v147
  v_dot2c_f32_bf16 v14, s60, v148
  v_dot2c_f32_bf16 v16, v148, v148
  v_dot2c_f32_bf16 v15, s60, v149
  v_dot2c_f32_bf16 v17, v149, v149
  v_dot2c_f32_bf16 v14, s60, v150
  v_dot2c_f32_bf16 v16, v150, v150
  v_dot2c_f32_bf16 v15, s60, v151
  v_dot2c_f32_bf16 v17, v151, v151
  v_dot2c_f32_bf16 v14, s60, v152
  v_dot2c_f32_bf16 v16, v152, v152
  v_dot2c_f32_bf16 v15, s60, v153
  v_dot2c_f32_bf16 v17, v153, v153
  v_dot2c_f32_bf16 v14, s60, v154
  v_dot2c_f32_bf16 v16, v154, v154
  v_dot2c_f32_bf16 v15, s60, v155
  v_dot2c_f32_bf16 v17, v155, v155
  v_dot2c_f32_bf16 v14, s60, v156
  v_dot2c_f32_bf16 v16, v156, v156
  v_dot2c_f32_bf16 v15, s60, v157
  v_dot2c_f32_bf16 v17, v157, v157
  v_dot2c_f32_bf16 v14, s60, v158
  v_dot2c_f32_bf16 v16, v158, v158
  v_dot2c_f32_bf16 v15, s60, v159
  v_dot2c_f32_bf16 v17, v159, v159
  v_mfma_f32_32x32x16_bf16 v[32:47], v[80:83], v[128:131], 0
  s_mul_i32 s55, s55, 172032
  s_add_u32 m0, s93, 9216
  s_add_u32 s55, s55, s91
  s_sub_u32 s62, s55, 128
  buffer_load_dwordx4 v5, s[12:15], s55 offen lds
  v_mfma_f32_32x32x16_bf16 v[48:63], v[128:131], v[84:87], 0
  buffer_load_dwordx4 v5, s[12:15], s62 offen offset:1024 lds
  s_lshl_b32 s61, s56, 7
  s_add_u32 m0, s92, 0
  s_add_u32 s61, s61, s59
  buffer_load_dwordx4 v1, s[8:11], s61 offen lds
  s_waitcnt lgkmcnt(0)
  v_mfma_f32_32x32x16_bf16 v[32:47], v[88:91], v[132:135], v[32:47]
  buffer_load_dwordx4 v2, s[8:11], s61 offen offset:1024 lds
  buffer_load_dwordx4 v3, s[8:11], s61 offen offset:2048 lds
  buffer_load_dwordx4 v4, s[8:11], s61 offen offset:3072 lds
  s_lshl_b32 s47, s95, 5
  s_lshl_b32 s98, s94, 3
  s_add_u32 s47, s47, s98
  s_lshr_b32 s98, s50, 2
  s_add_u32 s47, s47, s98
  s_mov_b32 s60, 0x3f803f80
  s_mov_b32 s86, -1
  s_mov_b32 s87, 0
  s_mov_b32 s96, 0
  s_mov_b32 s97, 0
  s_lshr_b32 s98, s50, 2
  s_sub_u32 s98, s50, s98
  s_sub_u32 s98, s98, 1
  s_mul_i32 s99, s51, 7
  s_add_u32 s3, s98, s99
  s_cmp_lt_u32 s50, 10
  s_cselect_b32 s3, s3, -1
  s_cmp_eq_u32 s48, 0
  s_cselect_b32 s3, -1, s3
  s_mul_i32 s99, s51, 14
  s_sub_u32 s98, s50, 10
  s_add_u32 s4, s98, s99
  s_cmp_lt_u32 s98, 14
  s_cselect_b32 s4, s4, -1
  s_mul_i32 s7, s47, 28672
  s_mul_i32 s98, s48, 224
  s_add_u32 s7, s7, s98
  s_mov_b32 s16, s84
  s_mov_b32 s17, s85
  s_mov_b32 s18, 16777216
  s_mov_b32 s19, 0x20000
  s_waitcnt vmcnt(13)
  s_barrier
  v_mfma_f32_32x32x16_bf16 v[48:63], v[132:135], v[92:95], v[48:63]
  ds_read_b64_tr_b16 v[64:65], v10 offset:3072
  ds_read_b64_tr_b16 v[66:67], v10 offset:3328
  ds_read_b64_tr_b16 v[68:69], v10 offset:4096
  ds_read_b64_tr_b16 v[70:71], v10 offset:4352
  v_mfma_f32_32x32x16_bf16 v[32:47], v[240:243], v[136:139], v[32:47]
  ds_read_b128 v[160:163], v6 offset:8192
  ds_read_b128 v[164:167], v7 offset:8192
  ds_read_b128 v[168:171], v8 offset:8192
  ds_read_b128 v[172:175], v9 offset:8192
  v_mfma_f32_32x32x16_bf16 v[48:63], v[136:139], v[244:247], v[48:63]
  ds_read_b64_tr_b16 v[72:73], v11 offset:3072
  ds_read_b64_tr_b16 v[74:75], v11 offset:3328
  ds_read_b64_tr_b16 v[76:77], v11 offset:4096
  ds_read_b64_tr_b16 v[78:79], v11 offset:4352
  v_mfma_f32_32x32x16_bf16 v[32:47], v[248:251], v[140:143], v[32:47]
  ds_read_b64_tr_b16 v[108:109], v12 offset:3072
  ds_read_b64_tr_b16 v[110:111], v12 offset:3328
  ds_read_b64_tr_b16 v[112:113], v12 offset:4096
  ds_read_b64_tr_b16 v[114:115], v12 offset:4352
  v_mfma_f32_32x32x16_bf16 v[48:63], v[140:143], v[252:255], v[48:63]
  ds_read_b64_tr_b16 v[116:117], v13 offset:3072
  ds_read_b64_tr_b16 v[118:119], v13 offset:3328
  ds_read_b64_tr_b16 v[120:121], v13 offset:4096
  ds_read_b64_tr_b16 v[122:123], v13 offset:4352
  s_waitcnt lgkmcnt(12)
  v_dot2c_f32_bf16 v18, s60, v64
  v_dot2c_f32_bf16 v19, s60, v68
  v_dot2c_f32_bf16 v18, s60, v65
  v_dot2c_f32_bf16 v19, s60, v69
  v_dot2c_f32_bf16 v18, s60, v66
  v_dot2c_f32_bf16 v19, s60, v70
  v_dot2c_f32_bf16 v18, s60, v67
  v_dot2c_f32_bf16 v19, s60, v71
  v_dot2c_f32_bf16 v14, s60, v160
  v_dot2c_f32_bf16 v16, v160, v160
  v_dot2c_f32_bf16 v15, s60, v161
  v_dot2c_f32_bf16 v17, v161, v161
  v_dot2c_f32_bf16 v14, s60, v162
  v_dot2c_f32_bf16 v16, v162, v162
  v_dot2c_f32_bf16 v15, s60, v163
  v_dot2c_f32_bf16 v17, v163, v163
  v_dot2c_f32_bf16 v14, s60, v164
  v_dot2c_f32_bf16 v16, v164, v164
  v_dot2c_f32_bf16 v15, s60, v165
  v_dot2c_f32_bf16 v17, v165, v165
  v_dot2c_f32_bf16 v14, s60, v166
  v_dot2c_f32_bf16 v16, v166, v166
  v_dot2c_f32_bf16 v15, s60, v167
  v_dot2c_f32_bf16 v17, v167, v167
  v_dot2c_f32_bf16 v14, s60, v168
  v_dot2c_f32_bf16 v16, v168, v168
  v_dot2c_f32_bf16 v15, s60, v169
  v_dot2c_f32_bf16 v17, v169, v169
  v_dot2c_f32_bf16 v14, s60, v170
  v_dot2c_f32_bf16 v16, v170, v170
  v_dot2c_f32_bf16 v15, s60, v171
  v_dot2c_f32_bf16 v17, v171, v171
  v_dot2c_f32_bf16 v14, s60, v172
  v_dot2c_f32_bf16 v16, v172, v172
  v_dot2c_f32_bf16 v15, s60, v173
  v_dot2c_f32_bf16 v17, v173, v173
  v_dot2c_f32_bf16 v14, s60, v174
  v_dot2c_f32_bf16 v16, v174, v174
  v_dot2c_f32_bf16 v15, s60, v175
  v_dot2c_f32_bf16 v17, v175, v175
  v_mfma_f32_32x32x16_bf16 v[32:47], v[64:67], v[144:147], v[32:47]
  s_mul_i32 s56, s56, 172032
  s_add_u32 m0, s93, 12288
  s_add_u32 s56, s56, s91
  s_sub_u32 s62, s56, 128
  buffer_load_dwordx4 v5, s[12:15], s56 offen lds
  v_mfma_f32_32x32x16_bf16 v[48:63], v[144:147], v[68:71], v[48:63]
  buffer_load_dwordx4 v5, s[12:15], s62 offen offset:1024 lds
  s_lshl_b32 s61, s57, 7
  s_add_u32 m0, s92, 4096
  s_add_u32 s61, s61, s59
  buffer_load_dwordx4 v1, s[8:11], s61 offen lds
  s_waitcnt lgkmcnt(0)
  v_mfma_f32_32x32x16_bf16 v[32:47], v[72:75], v[148:151], v[32:47]
  buffer_load_dwordx4 v2, s[8:11], s61 offen offset:1024 lds
  buffer_load_dwordx4 v3, s[8:11], s61 offen offset:2048 lds
  buffer_load_dwordx4 v4, s[8:11], s61 offen offset:3072 lds
  s_mov_b32 s24, s80
  s_mov_b32 s25, s81
  s_mov_b32 s26, 1835008
  s_mov_b32 s27, 0x20000
  s_mov_b32 s40, s72
  s_mov_b32 s41, s73
  s_mov_b32 s42, 896
  s_mov_b32 s43, 0x20000
  v_mov_b32 v20, 0
  v_mov_b32 v21, 0
  v_mov_b32 v97, 0
  v_mov_b32 v98, 0
  v_mov_b32 v99, 0
  v_mov_b32 v101, 0
  v_mov_b32 v102, 0
  v_mov_b32 v103, 0
  v_mov_b32 v105, 0
  v_mov_b32 v106, 0
  v_mov_b32 v107, 0
  v_lshlrev_b32 v26, 4, v0
  v_add_u32 v26, 155648, v26
  s_add_u32 s99, s44, 1
  s_and_b32 s99, s99, 3
  v_lshl_add_u32 v124, s99, 11, v26
  s_add_u32 s99, s44, 2
  s_and_b32 s99, s99, 3
  v_lshl_add_u32 v125, s99, 11, v26
  s_add_u32 s99, s44, 3
  s_and_b32 s99, s99, 3
  v_lshl_add_u32 v126, s99, 11, v26
  s_add_u32 s99, s44, 4
  s_waitcnt vmcnt(13)
  s_barrier
  v_mfma_f32_32x32x16_bf16 v[48:63], v[148:151], v[76:79], v[48:63]
  ds_read_b64_tr_b16 v[80:81], v10 offset:6144
  ds_read_b64_tr_b16 v[82:83], v10 offset:6400
  ds_read_b64_tr_b16 v[84:85], v10 offset:7168
  ds_read_b64_tr_b16 v[86:87], v10 offset:7424
  v_mfma_f32_32x32x16_bf16 v[32:47], v[108:111], v[152:155], v[32:47]
  ds_read_b128 v[176:179], v6 offset:12288
  ds_read_b128 v[180:183], v7 offset:12288
  ds_read_b128 v[184:187], v8 offset:12288
  ds_read_b128 v[188:191], v9 offset:12288
  v_mfma_f32_32x32x16_bf16 v[48:63], v[152:155], v[112:115], v[48:63]
  ds_read_b64_tr_b16 v[88:89], v11 offset:6144
  ds_read_b64_tr_b16 v[90:91], v11 offset:6400
  ds_read_b64_tr_b16 v[92:93], v11 offset:7168
  ds_read_b64_tr_b16 v[94:95], v11 offset:7424
  v_mfma_f32_32x32x16_bf16 v[32:47], v[116:119], v[156:159], v[32:47]
  ds_read_b64_tr_b16 v[240:241], v12 offset:6144
  ds_read_b64_tr_b16 v[242:243], v12 offset:6400
  ds_read_b64_tr_b16 v[244:245], v12 offset:7168
  ds_read_b64_tr_b16 v[246:247], v12 offset:7424
  v_mfma_f32_32x32x16_bf16 v[48:63], v[156:159], v[120:123], v[48:63]
  ds_read_b64_tr_b16 v[248:249], v13 offset:6144
  ds_read_b64_tr_b16 v[250:251], v13 offset:6400
  ds_read_b64_tr_b16 v[252:253], v13 offset:7168
  ds_read_b64_tr_b16 v[254:255], v13 offset:7424
  s_waitcnt lgkmcnt(12)
  v_dot2c_f32_bf16 v18, s60, v80
  v_dot2c_f32_bf16 v19, s60, v84
  v_dot2c_f32_bf16 v18, s60, v81
  v_dot2c_f32_bf16 v19, s60, v85
  v_dot2c_f32_bf16 v18, s60, v82
  v_dot2c_f32_bf16 v19, s60, v86
  v_dot2c_f32_bf16 v18, s60, v83
  v_dot2c_f32_bf16 v19, s60, v87
  v_dot2c_f32_bf16 v14, s60, v176
  v_dot2c_f32_bf16 v16, v176, v176
  v_dot2c_f32_bf16 v15, s60, v177
  v_dot2c_f32_bf16 v17, v177, v177
  v_dot2c_f32_bf16 v14, s60, v178
  v_dot2c_f32_bf16 v16, v178, v178
  v_dot2c_f32_bf16 v15, s60, v179
  v_dot2c_f32_bf16 v17, v179, v179
  v_dot2c_f32_bf16 v14, s60, v180
  v_dot2c_f32_bf16 v16, v180, v180
  v_dot2c_f32_bf16 v15, s60, v181
  v_dot2c_f32_bf16 v17, v181, v181
  v_dot2c_f32_bf16 v14, s60, v182
  v_dot2c_f32_bf16 v16, v182, v182
  v_dot2c_f32_bf16 v15, s60, v183
  v_dot2c_f32_bf16 v17, v183, v183
  v_dot2c_f32_bf16 v14, s60, v184
  v_dot2c_f32_bf16 v16, v184, v184
  v_dot2c_f32_bf16 v15, s60, v185
  v_dot2c_f32_bf16 v17, v185, v185
  v_dot2c_f32_bf16 v14, s60, v186
  v_dot2c_f32_bf16 v16, v186, v186
  v_dot2c_f32_bf16 v15, s60, v187
  v_dot2c_f32_bf16 v17, v187, v187
  v_dot2c_f32_bf16 v14, s60, v188
  v_dot2c_f32_bf16 v16, v188, v188
  v_dot2c_f32_bf16 v15, s60, v189
  v_dot2c_f32_bf16 v17, v189, v189
  v_dot2c_f32_bf16 v14, s60, v190
  v_dot2c_f32_bf16 v16, v190, v190
  v_dot2c_f32_bf16 v15, s60, v191
  v_dot2c_f32_bf16 v17, v191, v191
  v_mfma_f32_32x32x16_bf16 v[32:47], v[80:83], v[160:163], v[32:47]
  s_mul_i32 s57, s57, 172032
  s_add_u32 m0, s93, 15360
  s_add_u32 s57, s57, s91
  s_sub_u32 s62, s57, 128
  buffer_load_dwordx4 v5, s[12:15], s57 offen lds
  v_mfma_f32_32x32x16_bf16 v[48:63], v[160:163], v[84:87], v[48:63]
  buffer_load_dwordx4 v5, s[12:15], s62 offen offset:1024 lds
  s_lshl_b32 s61, s58, 7
  s_add_u32 m0, s92, 8192
  s_add_u32 s61, s61, s59
  buffer_load_dwordx4 v1, s[8:11], s61 offen lds
  s_waitcnt lgkmcnt(0)
  v_mfma_f32_32x32x16_bf16 v[32:47], v[88:91], v[164:167], v[32:47]
  buffer_load_dwordx4 v2, s[8:11], s61 offen offset:1024 lds
  buffer_load_dwordx4 v3, s[8:11], s61 offen offset:2048 lds
  buffer_load_dwordx4 v4, s[8:11], s61 offen offset:3072 lds
  s_and_b32 s99, s99, 3
  v_lshl_add_u32 v127, s99, 11, v26
  s_lshl_b32 s99, s45, 2
  s_add_u32 s99, s99, s44
  s_lshl_b32 s99, s99, 7
  s_add_u32 s82, s99, 4096
  s_lshl_b32 s99, s46, 2
  s_add_u32 s83, s99, s82
  s_lshl_b32 s99, s45, 6
  s_add_u32 s99, s99, s44
  s_mul_i32 s99, s99, 4352
  s_add_u32 s99, s99, 1048576
  v_add_u32 v26, s46, v0
  v_and_b32 v26, 15, v26
  v_mul_u32_u24 v26, 17408, v26
  v_add_u32 v26, s99, v26
  s_nop 0
  v_readlane_b32 s64, v26, 0
  v_readlane_b32 s65, v26, 1
  v_readlane_b32 s66, v26, 2
  v_readlane_b32 s67, v26, 3
  v_readlane_b32 s68, v26, 4
  v_readlane_b32 s69, v26, 5
  v_readlane_b32 s70, v26, 6
  v_readlane_b32 s71, v26, 7
  v_readlane_b32 s72, v26, 8
  v_readlane_b32 s73, v26, 9
  v_readlane_b32 s74, v26, 10
  v_readlane_b32 s75, v26, 11
  v_readlane_b32 s76, v26, 12
  v_readlane_b32 s77, v26, 13
  v_readlane_b32 s78, v26, 14
  s_waitcnt vmcnt(12)
  s_barrier
  v_mfma_f32_32x32x16_bf16 v[48:63], v[164:167], v[92:95], v[48:63]
  ds_read_b64_tr_b16 v[64:65], v10 offset:9216
  ds_read_b64_tr_b16 v[66:67], v10 offset:9472
  ds_read_b64_tr_b16 v[68:69], v10 offset:10240
  ds_read_b64_tr_b16 v[70:71], v10 offset:10496
  v_mfma_f32_32x32x16_bf16 v[32:47], v[240:243], v[168:171], v[32:47]
  ds_read_b128 v[192:195], v6 offset:0
  ds_read_b128 v[196:199], v7 offset:0
  ds_read_b128 v[200:203], v8 offset:0
  ds_read_b128 v[204:207], v9 offset:0
  v_mfma_f32_32x32x16_bf16 v[48:63], v[168:171], v[244:247], v[48:63]
  ds_read_b64_tr_b16 v[72:73], v11 offset:9216
  ds_read_b64_tr_b16 v[74:75], v11 offset:9472
  ds_read_b64_tr_b16 v[76:77], v11 offset:10240
  ds_read_b64_tr_b16 v[78:79], v11 offset:10496
  v_mfma_f32_32x32x16_bf16 v[32:47], v[248:251], v[172:175], v[32:47]
  ds_read_b64_tr_b16 v[108:109], v12 offset:9216
  ds_read_b64_tr_b16 v[110:111], v12 offset:9472
  ds_read_b64_tr_b16 v[112:113], v12 offset:10240
  ds_read_b64_tr_b16 v[114:115], v12 offset:10496
  v_mfma_f32_32x32x16_bf16 v[48:63], v[172:175], v[252:255], v[48:63]
  ds_read_b64_tr_b16 v[116:117], v13 offset:9216
  ds_read_b64_tr_b16 v[118:119], v13 offset:9472
  ds_read_b64_tr_b16 v[120:121], v13 offset:10240
  ds_read_b64_tr_b16 v[122:123], v13 offset:10496
  s_waitcnt lgkmcnt(12)
  v_dot2c_f32_bf16 v18, s60, v64
  v_dot2c_f32_bf16 v19, s60, v68
  v_dot2c_f32_bf16 v18, s60, v65
  v_dot2c_f32_bf16 v19, s60, v69
  v_dot2c_f32_bf16 v18, s60, v66
  v_dot2c_f32_bf16 v19, s60, v70
  v_dot2c_f32_bf16 v18, s60, v67
  v_dot2c_f32_bf16 v19, s60, v71
  v_dot2c_f32_bf16 v14, s60, v192
  v_dot2c_f32_bf16 v16, v192, v192
  v_dot2c_f32_bf16 v15, s60, v193
  v_dot2c_f32_bf16 v17, v193, v193
  v_dot2c_f32_bf16 v14, s60, v194
  v_dot2c_f32_bf16 v16, v194, v194
  v_dot2c_f32_bf16 v15, s60, v195
  v_dot2c_f32_bf16 v17, v195, v195
  v_dot2c_f32_bf16 v14, s60, v196
  v_dot2c_f32_bf16 v16, v196, v196
  v_dot2c_f32_bf16 v15, s60, v197
  v_dot2c_f32_bf16 v17, v197, v197
  v_dot2c_f32_bf16 v14, s60, v198
  v_dot2c_f32_bf16 v16, v198, v198
  v_dot2c_f32_bf16 v15, s60, v199
  v_dot2c_f32_bf16 v17, v199, v199
  v_dot2c_f32_bf16 v14, s60, v200
  v_dot2c_f32_bf16 v16, v200, v200
  v_dot2c_f32_bf16 v15, s60, v201
  v_dot2c_f32_bf16 v17, v201, v201
  v_dot2c_f32_bf16 v14, s60, v202
  v_dot2c_f32_bf16 v16, v202, v202
  v_dot2c_f32_bf16 v15, s60, v203
  v_dot2c_f32_bf16 v17, v203, v203
  v_dot2c_f32_bf16 v14, s60, v204
  v_dot2c_f32_bf16 v16, v204, v204
  v_dot2c_f32_bf16 v15, s60, v205
  v_dot2c_f32_bf16 v17, v205, v205
  v_dot2c_f32_bf16 v14, s60, v206
  v_dot2c_f32_bf16 v16, v206, v206
  v_dot2c_f32_bf16 v15, s60, v207
  v_dot2c_f32_bf16 v17, v207, v207
  v_mfma_f32_32x32x16_bf16 v[32:47], v[64:67], v[176:179], v[32:47]
  s_mul_i32 s58, s58, 172032
  s_add_u32 m0, s93, 18432
  s_add_u32 s58, s58, s91
  s_sub_u32 s62, s58, 128
  v_mfma_f32_32x32x16_bf16 v[48:63], v[176:179], v[68:71], v[48:63]
  buffer_load_dwordx4 v5, s[12:15], s58 offen lds
  buffer_load_dwordx4 v5, s[12:15], s62 offen offset:1024 lds
  v_readfirstlane_b32 s49, v30
  s_mul_i32 s49, s49, 0x19660d
  s_waitcnt lgkmcnt(0)
  v_mfma_f32_32x32x16_bf16 v[32:47], v[72:75], v[180:183], v[32:47]
  s_add_u32 s49, s49, 0x3c6ef35f
  v_mov_b32 v30, s49
  v_readlane_b32 s79, v26, 15
  s_lshl_b32 s98, s46, 2
  s_add_u32 s98, s98, s44
  s_lshl_b32 s98, s98, 4
  s_add_u32 s98, s98, s45
  s_lshl_b32 s98, s98, 11
  s_add_u32 s99, s98, 5767168
  s_mul_i32 s35, s44, 56
  s_add_u32 s34, s7, s35
  s_mul_i32 s98, s48, 224
  s_add_u32 s35, s35, s98
  s_lshl_b32 s94, s44, 8
  s_add_u32 s94, s94, 12288
  s_add_u32 s98, s44, 1
  s_and_b32 s98, s98, 3
  s_mul_i32 s98, s98, 12288
  s_add_u32 s36, s98, 114688
  s_add_u32 s98, s44, 2
  s_and_b32 s98, s98, 3
  s_mul_i32 s98, s98, 12288
  s_add_u32 s37, s98, 118784
  s_add_u32 s98, s44, 3
  s_and_b32 s98, s98, 3
  s_mul_i32 s98, s98, 12288
  s_add_u32 s38, s98, 122880
  s_add_u32 s98, s44, 4
  s_and_b32 s98, s98, 3
  s_mul_i32 s98, s98, 12288
  s_add_u32 s39, s98, 114688
  s_waitcnt vmcnt(8)
  s_barrier
  v_mfma_f32_32x32x16_bf16 v[48:63], v[180:183], v[76:79], v[48:63]
  ds_read_b64_tr_b16 v[80:81], v10 offset:12288
  ds_read_b64_tr_b16 v[82:83], v10 offset:12544
  ds_read_b64_tr_b16 v[84:85], v10 offset:13312
  ds_read_b64_tr_b16 v[86:87], v10 offset:13568
  v_mfma_f32_32x32x16_bf16 v[32:47], v[108:111], v[184:187], v[32:47]
  ds_read_b128 v[208:211], v6 offset:4096
  ds_read_b128 v[212:215], v7 offset:4096
  ds_read_b128 v[216:219], v8 offset:4096
  ds_read_b128 v[220:223], v9 offset:4096
  v_mfma_f32_32x32x16_bf16 v[48:63], v[184:187], v[112:115], v[48:63]
  ds_read_b64_tr_b16 v[88:89], v11 offset:12288
  ds_read_b64_tr_b16 v[90:91], v11 offset:12544
  ds_read_b64_tr_b16 v[92:93], v11 offset:13312
  ds_read_b64_tr_b16 v[94:95], v11 offset:13568
  v_mfma_f32_32x32x16_bf16 v[32:47], v[116:119], v[188:191], v[32:47]
  ds_read_b64_tr_b16 v[240:241], v12 offset:12288
  ds_read_b64_tr_b16 v[242:243], v12 offset:12544
  ds_read_b64_tr_b16 v[244:245], v12 offset:13312
  ds_read_b64_tr_b16 v[246:247], v12 offset:13568
  v_mfma_f32_32x32x16_bf16 v[48:63], v[188:191], v[120:123], v[48:63]
  ds_read_b64_tr_b16 v[248:249], v13 offset:12288
  ds_read_b64_tr_b16 v[250:251], v13 offset:12544
  ds_read_b64_tr_b16 v[252:253], v13 offset:13312
  ds_read_b64_tr_b16 v[254:255], v13 offset:13568
  s_waitcnt lgkmcnt(12)
  v_dot2c_f32_bf16 v18, s60, v80
  v_dot2c_f32_bf16 v19, s60, v84
  v_dot2c_f32_bf16 v18, s60, v81
  v_dot2c_f32_bf16 v19, s60, v85
  v_dot2c_f32_bf16 v18, s60, v82
  v_dot2c_f32_bf16 v19, s60, v86
  v_dot2c_f32_bf16 v18, s60, v83
  v_dot2c_f32_bf16 v19, s60, v87
  v_dot2c_f32_bf16 v14, s60, v208
  v_dot2c_f32_bf16 v16, v208, v208
  v_dot2c_f32_bf16 v15, s60, v209
  v_dot2c_f32_bf16 v17, v209, v209
  v_dot2c_f32_bf16 v14, s60, v210
  v_dot2c_f32_bf16 v16, v210, v210
  v_dot2c_f32_bf16 v15, s60, v211
  v_dot2c_f32_bf16 v17, v211, v211
  v_dot2c_f32_bf16 v14, s60, v212
  v_dot2c_f32_bf16 v16, v212, v212
  v_dot2c_f32_bf16 v15, s60, v213
  v_dot2c_f32_bf16 v17, v213, v213
  v_dot2c_f32_bf16 v14, s60, v214
  v_dot2c_f32_bf16 v16, v214, v214
  v_dot2c_f32_bf16 v15, s60, v215
  v_dot2c_f32_bf16 v17, v215, v215
  v_dot2c_f32_bf16 v14, s60, v216
  v_dot2c_f32_bf16 v16, v216, v216
  v_dot2c_f32_bf16 v15, s60, v217
  v_dot2c_f32_bf16 v17, v217, v217
  v_dot2c_f32_bf16 v14, s60, v218
  v_dot2c_f32_bf16 v16, v218, v218
  v_dot2c_f32_bf16 v15, s60, v219
  v_dot2c_f32_bf16 v17, v219, v219
  v_dot2c_f32_bf16 v14, s60, v220
  v_dot2c_f32_bf16 v16, v220, v220
  v_dot2c_f32_bf16 v15, s60, v221
  v_dot2c_f32_bf16 v17, v221, v221
  v_dot2c_f32_bf16 v14, s60, v222
  v_dot2c_f32_bf16 v16, v222, v222
  v_dot2c_f32_bf16 v15, s60, v223
  v_dot2c_f32_bf16 v17, v223, v223
  v_mfma_f32_32x32x16_bf16 v[32:47], v[80:83], v[192:195], v[32:47]
  s_add_u32 m0, s93, 2048
  s_sub_u32 s62, s52, 896
  buffer_load_dwordx4 v5, s[12:15], s62 offen lds
  s_add_u32 m0, s93, 5120
  s_sub_u32 s62, s53, 896
  buffer_load_dwordx4 v5, s[12:15], s62 offen lds
  s_add_u32 m0, s93, 8192
  v_mfma_f32_32x32x16_bf16 v[48:63], v[192:195], v[84:87], v[48:63]
  s_sub_u32 s62, s54, 896
  buffer_load_dwordx4 v5, s[12:15], s62 offen lds
  s_add_u32 m0, s93, 11264
  s_sub_u32 s62, s55, 896
  buffer_load_dwordx4 v5, s[12:15], s62 offen lds
  v_and_b32 v22, 31, v0
  v_lshlrev_b32 v22, 5, v22
  s_waitcnt lgkmcnt(0)
  v_mfma_f32_32x32x16_bf16 v[32:47], v[88:91], v[196:199], v[32:47]
  v_add_u32 v23, 151552, v22
  v_lshrrev_b32 v24, 5, v0
  s_lshl_b32 s61, s44, 3
  v_lshl_add_u32 v24, v24, 2, v23
  v_add_u32 v24, s61, v24
  s_waitcnt vmcnt(6)
  s_barrier
  v_mfma_f32_32x32x16_bf16 v[48:63], v[196:199], v[92:95], v[48:63]
  ds_read_b64_tr_b16 v[64:65], v10 offset:15360
  ds_read_b64_tr_b16 v[66:67], v10 offset:15616
  ds_read_b64_tr_b16 v[68:69], v10 offset:16384
  ds_read_b64_tr_b16 v[70:71], v10 offset:16640
  v_mfma_f32_32x32x16_bf16 v[32:47], v[240:243], v[200:203], v[32:47]
  ds_read_b128 v[224:227], v6 offset:8192
  ds_read_b128 v[228:231], v7 offset:8192
  ds_read_b128 v[232:235], v8 offset:8192
  ds_read_b128 v[236:239], v9 offset:8192
  v_mfma_f32_32x32x16_bf16 v[48:63], v[200:203], v[244:247], v[48:63]
  ds_read_b64_tr_b16 v[72:73], v11 offset:15360
  ds_read_b64_tr_b16 v[74:75], v11 offset:15616
  ds_read_b64_tr_b16 v[76:77], v11 offset:16384
  ds_read_b64_tr_b16 v[78:79], v11 offset:16640
  v_mfma_f32_32x32x16_bf16 v[32:47], v[248:251], v[204:207], v[32:47]
  ds_read_b64_tr_b16 v[108:109], v12 offset:15360
  ds_read_b64_tr_b16 v[110:111], v12 offset:15616
  ds_read_b64_tr_b16 v[112:113], v12 offset:16384
  ds_read_b64_tr_b16 v[114:115], v12 offset:16640
  v_mfma_f32_32x32x16_bf16 v[48:63], v[204:207], v[252:255], v[48:63]
  ds_read_b64_tr_b16 v[116:117], v13 offset:15360
  ds_read_b64_tr_b16 v[118:119], v13 offset:15616
  ds_read_b64_tr_b16 v[120:121], v13 offset:16384
  ds_read_b64_tr_b16 v[122:123], v13 offset:16640
  s_waitcnt lgkmcnt(12)
  v_dot2c_f32_bf16 v18, s60, v64
  v_dot2c_f32_bf16 v19, s60, v68
  v_dot2c_f32_bf16 v18, s60, v65
  v_dot2c_f32_bf16 v19, s60, v69
  v_dot2c_f32_bf16 v18, s60, v66
  v_dot2c_f32_bf16 v19, s60, v70
  v_dot2c_f32_bf16 v18, s60, v67
  v_dot2c_f32_bf16 v19, s60, v71
  v_dot2c_f32_bf16 v14, s60, v224
  v_dot2c_f32_bf16 v16, v224, v224
  v_dot2c_f32_bf16 v15, s60, v225
  v_dot2c_f32_bf16 v17, v225, v225
  v_dot2c_f32_bf16 v14, s60, v226
  v_dot2c_f32_bf16 v16, v226, v226
  v_dot2c_f32_bf16 v15, s60, v227
  v_dot2c_f32_bf16 v17, v227, v227
  v_dot2c_f32_bf16 v14, s60, v228
  v_dot2c_f32_bf16 v16, v228, v228
  v_dot2c_f32_bf16 v15, s60, v229
  v_dot2c_f32_bf16 v17, v229, v229
  v_dot2c_f32_bf16 v14, s60, v230
  v_dot2c_f32_bf16 v16, v230, v230
  v_dot2c_f32_bf16 v15, s60, v231
  v_dot2c_f32_bf16 v17, v231, v231
  v_dot2c_f32_bf16 v14, s60, v232
  v_dot2c_f32_bf16 v16, v232, v232
  v_dot2c_f32_bf16 v15, s60, v233
  v_dot2c_f32_bf16 v17, v233, v233
  v_dot2c_f32_bf16 v14, s60, v234
  v_dot2c_f32_bf16 v16, v234, v234
  v_dot2c_f32_bf16 v15, s60, v235
  v_dot2c_f32_bf16 v17, v235, v235
  v_dot2c_f32_bf16 v14, s60, v236
  v_dot2c_f32_bf16 v16, v236, v236
  v_dot2c_f32_bf16 v15, s60, v237
  v_dot2c_f32_bf16 v17, v237, v237
  v_dot2c_f32_bf16 v14, s60, v238
  v_dot2c_f32_bf16 v16, v238, v238
  v_dot2c_f32_bf16 v15, s60, v239
  v_dot2c_f32_bf16 v17, v239, v239
  v_mfma_f32_32x32x16_bf16 v[32:47], v[64:67], v[208:211], v[32:47]
  s_add_u32 m0, s93, 14336
  s_sub_u32 s62, s56, 896
  buffer_load_dwordx4 v5, s[12:15], s62 offen lds
  v_mfma_f32_32x32x16_bf16 v[48:63], v[208:211], v[68:71], v[48:63]
  s_add_u32 m0, s93, 17408
  s_sub_u32 s62, s57, 896
  buffer_load_dwordx4 v5, s[12:15], s62 offen lds
  s_waitcnt lgkmcnt(0)
  v_mfma_f32_32x32x16_bf16 v[32:47], v[72:75], v[212:215], v[32:47]
  s_add_u32 m0, s93, 20480
  s_sub_u32 s62, s58, 896
  buffer_load_dwordx4 v5, s[12:15], s62 offen lds
  v_add_f32 v14, v14, v15
  v_add_f32 v16, v16, v17
  s_nop 1
  v_permlane32_swap_b32 v14, v16
  v_add_f32 v14, v14, v16
  v_mov_b32 v16, v14
  s_nop 1
  v_permlane32_swap_b32 v14, v16
  v_mul_f32 v26, 0x3b124925, v14
  v_mul_f32 v15, 0x3b124925, v16
  v_fma_f32 v15, -v26, v26, v15
  v_max_f32 v15, 0, v15
  v_cvt_pk_bf16_f32 v17, v26, v15
  v_lshlrev_b32 v26, 16, v17
  v_and_b32 v15, 0xffff0000, v17
  v_add_f32 v15, 0x3727c5ac, v15
  v_cvt_pk_bf16_f32 v15, v15, v15
  v_and_b32 v15, 0xffff0000, v15
  v_sqrt_f32 v15, v15
  s_nop 0
  v_cvt_pk_bf16_f32 v15, v15, v15
  v_and_b32 v15, 0xffff0000, v15
  v_rcp_f32 v28, v15
  v_lshrrev_b32 v15, 16, v26
  v_or_b32 v15, v15, v26
  v_cndmask_b32 v96, 0, v15, s[86:87]
  v_and_b32 v15, 31, v0
  s_lshl_b32 s61, s44, 7
  s_add_u32 s61, s61, 154624
  v_lshl_add_u32 v15, v15, 2, s61
  v_lshrrev_b32 v25, 5, v0
  v_lshl_add_u32 v25, v25, 4, s61
  ds_write_b32 v15, v28
  v_lshlrev_b32 v1, 4, v0
  v_lshlrev_b32 v6, 2, v0
  v_add_u32 v6, 4096, v6
  v_and_b32 v9, 31, v0
  v_cmp_gt_u32 vcc, 28, v9
  v_mov_b32 v2, s60
  v_mov_b32 v3, 0x3f80
  v_cndmask_b32 v4, 0, -1, vcc
  v_cmp_eq_u32 vcc, 28, v9
  s_nop 1
  v_cndmask_b32 v9, 0, v2, vcc
  s_waitcnt vmcnt(7)
  s_barrier
  v_mfma_f32_32x32x16_bf16 v[48:63], v[212:215], v[76:79], v[48:63]
  ds_read_b64_tr_b16 v[80:81], v10 offset:18432
  ds_read_b64_tr_b16 v[82:83], v10 offset:18688
  ds_read_b64_tr_b16 v[84:85], v10 offset:19456
  ds_read_b64_tr_b16 v[86:87], v10 offset:19712
  v_mfma_f32_32x32x16_bf16 v[32:47], v[108:111], v[216:219], v[32:47]
  ds_read_b64_tr_b16 v[88:89], v11 offset:18432
  ds_read_b64_tr_b16 v[90:91], v11 offset:18688
  ds_read_b64_tr_b16 v[92:93], v11 offset:19456
  ds_read_b64_tr_b16 v[94:95], v11 offset:19712
  v_mfma_f32_32x32x16_bf16 v[48:63], v[216:219], v[112:115], v[48:63]
  ds_read_b64_tr_b16 v[240:241], v12 offset:18432
  ds_read_b64_tr_b16 v[242:243], v12 offset:18688
  ds_read_b64_tr_b16 v[244:245], v12 offset:19456
  ds_read_b64_tr_b16 v[246:247], v12 offset:19712
  v_mfma_f32_32x32x16_bf16 v[32:47], v[116:119], v[220:223], v[32:47]
  ds_read_b64_tr_b16 v[248:249], v13 offset:18432
  ds_read_b64_tr_b16 v[250:251], v13 offset:18688
  ds_read_b64_tr_b16 v[252:253], v13 offset:19456
  ds_read_b64_tr_b16 v[254:255], v13 offset:19712
  v_mfma_f32_32x32x16_bf16 v[48:63], v[220:223], v[120:123], v[48:63]
  s_waitcnt lgkmcnt(12)
  v_dot2c_f32_bf16 v18, s60, v80
  v_dot2c_f32_bf16 v19, s60, v84
  v_dot2c_f32_bf16 v18, s60, v81
  v_dot2c_f32_bf16 v19, s60, v85
  v_dot2c_f32_bf16 v18, s60, v82
  v_dot2c_f32_bf16 v19, s60, v86
  v_dot2c_f32_bf16 v18, s60, v83
  v_dot2c_f32_bf16 v19, s60, v87
  s_nop 1
  ds_write_b32 v24, v18
  ds_write_b32 v24, v19 offset:1024
  v_mfma_f32_32x32x16_bf16 v[32:47], v[80:83], v[224:227], v[32:47]
  s_waitcnt lgkmcnt(0)
  s_barrier
  ds_read_b128 v[108:111], v23 offset:0
  ds_read_b128 v[112:115], v23 offset:16
  ds_read_b128 v[116:119], v23 offset:1024
  ds_read_b128 v[120:123], v23 offset:1040
  v_mfma_f32_32x32x16_bf16 v[32:47], v[88:91], v[228:231], v[32:47]
  ds_read_b128 v[64:67], v25 offset:0
  ds_read_b128 v[68:71], v25 offset:32
  ds_read_b128 v[72:75], v25 offset:64
  ds_read_b128 v[76:79], v25 offset:96
  v_mfma_f32_32x32x16_bf16 v[32:47], v[240:243], v[232:235], v[32:47]
  s_waitcnt lgkmcnt(6)
  v_add_f32 v108, v108, v109
  v_add_f32 v110, v110, v111
  v_add_f32 v112, v112, v113
  v_add_f32 v114, v114, v115
  v_add_f32 v108, v108, v110
  v_mfma_f32_32x32x16_bf16 v[32:47], v[248:251], v[236:239], v[32:47]
  v_add_f32 v112, v112, v114
  v_add_f32 v108, v108, v112
  v_cvt_pk_bf16_f32 v22, -v108, -v108
  v_and_b32 v22, 0xffff0000, v22
  v_sub_f32_e64 v100, -v108, v22
  v_cvt_pk_bf16_f32 v100, v22, v100
  v_mfma_f32_32x32x16_bf16 v[48:63], v[232:235], v[244:247], v[48:63]
  s_waitcnt lgkmcnt(4)
  v_mfma_f32_32x32x16_bf16 v[32:47], v[100:103], v[96:99], v[32:47]
  v_add_f32 v116, v116, v117
  v_add_f32 v118, v118, v119
  v_add_f32 v120, v120, v121
  v_add_f32 v122, v122, v123
  v_add_f32 v116, v116, v118
  v_add_f32 v120, v120, v122
  v_mfma_f32_32x32x16_bf16 v[48:63], v[236:239], v[252:255], v[48:63]
  v_add_f32 v116, v116, v120
  v_cvt_pk_bf16_f32 v22, -v116, -v116
  v_and_b32 v22, 0xffff0000, v22
  v_sub_f32_e64 v104, -v116, v22
  v_cvt_pk_bf16_f32 v104, v22, v104
  v_mfma_f32_32x32x16_bf16 v[48:63], v[224:227], v[84:87], v[48:63]
  v_mul_f32 v32, v32, v28
  v_mul_f32 v33, v33, v28
  v_mul_f32 v34, v34, v28
  v_mul_f32 v35, v35, v28
  v_mul_f32 v36, v36, v28
  v_mul_f32 v37, v37, v28
  v_mul_f32 v38, v38, v28
  v_mul_f32 v39, v39, v28
  v_mfma_f32_32x32x16_bf16 v[48:63], v[228:231], v[92:95], v[48:63]
  v_cvt_pk_bf16_f32 v240, v32, v33
  v_cvt_pk_bf16_f32 v241, v34, v35
  v_cvt_pk_bf16_f32 v242, v36, v37
  v_cvt_pk_bf16_f32 v243, v38, v39
  buffer_store_dwordx4 v[240:243], v1, s[16:19], s64 offen sc1
  v_mul_f32 v40, v40, v28
  v_mul_f32 v41, v41, v28
  v_mfma_f32_32x32x16_bf16 v[48:63], v[96:99], v[104:107], v[48:63]
  v_mul_f32 v42, v42, v28
  v_mul_f32 v43, v43, v28
  v_mul_f32 v44, v44, v28
  v_mul_f32 v45, v45, v28
  v_mul_f32 v46, v46, v28
  v_mul_f32 v47, v47, v28
  v_cvt_pk_bf16_f32 v244, v40, v41
  v_cvt_pk_bf16_f32 v245, v42, v43
  v_cvt_pk_bf16_f32 v246, v44, v45
  v_cvt_pk_bf16_f32 v247, v46, v47
  v_cndmask_b32 v246, v2, v246, s[86:87]
  v_cndmask_b32 v247, v3, v247, s[86:87]
  buffer_store_dwordx4 v[244:247], v1, s[16:19], s64 offen offset:1024 sc1
  s_waitcnt lgkmcnt(0)
  v_pk_mul_f32 v[48:49], v[48:49], v[64:65]
  v_pk_mul_f32 v[50:51], v[50:51], v[66:67]
  v_pk_mul_f32 v[52:53], v[52:53], v[68:69]
  v_pk_mul_f32 v[54:55], v[54:55], v[70:71]
  v_cvt_pk_bf16_f32 v248, v48, v49
  v_cvt_pk_bf16_f32 v249, v50, v51
  v_cvt_pk_bf16_f32 v250, v52, v53
  v_cvt_pk_bf16_f32 v251, v54, v55
  v_and_or_b32 v248, v248, v4, v9
  v_and_or_b32 v249, v249, v4, v9
  v_and_or_b32 v250, v250, v4, v9
  v_and_or_b32 v251, v251, v4, v9
  buffer_store_dwordx4 v[248:251], v1, s[16:19], s64 offen offset:2048 sc1
  v_pk_mul_f32 v[56:57], v[56:57], v[72:73]
  v_pk_mul_f32 v[58:59], v[58:59], v[74:75]
  v_pk_mul_f32 v[60:61], v[60:61], v[76:77]
  v_pk_mul_f32 v[62:63], v[62:63], v[78:79]
  v_cvt_pk_bf16_f32 v252, v56, v57
  v_cvt_pk_bf16_f32 v253, v58, v59
  v_cvt_pk_bf16_f32 v254, v60, v61
  v_cvt_pk_bf16_f32 v255, v62, v63
  v_and_or_b32 v252, v252, v4, v9
  v_and_or_b32 v253, v253, v4, v9
  v_and_or_b32 v254, v254, v4, v9
  v_and_or_b32 v255, v255, v4, v9
  buffer_store_dwordx4 v[252:255], v1, s[16:19], s64 offen offset:3072 sc1
  v_add3_u32 v7, v240, v241, v30
  v_add3_u32 v7, v242, v243, v7
  v_add3_u32 v7, v244, v245, v7
  v_add3_u32 v7, v246, v247, v7
  v_add3_u32 v7, v248, v249, v7
  v_add3_u32 v7, v250, v251, v7
  v_add3_u32 v7, v252, v253, v7
  v_add3_u32 v7, v254, v255, v7
  buffer_store_dword v7, v6, s[16:19], s64 offen sc1
  s_mov_b32 s90, 0xffff0000
  s_waitcnt vmcnt(10)
  s_barrier
  ds_read_b64_tr_b16 v[32:33], v10 offset:2048
  ds_read_b64_tr_b16 v[34:35], v10 offset:2304
  ds_read_b64_tr_b16 v[36:37], v11 offset:2048
  ds_read_b64_tr_b16 v[38:39], v11 offset:2304
  ds_read_b64_tr_b16 v[40:41], v12 offset:2048
  ds_read_b64_tr_b16 v[42:43], v12 offset:2304
  s_waitcnt lgkmcnt(4)
  v_mfma_f32_32x32x16_bf16 v[64:79], v[32:35], v[128:131], 0
  ds_read_b64_tr_b16 v[44:45], v13 offset:2048
  ds_read_b64_tr_b16 v[46:47], v13 offset:2304
  v_lshlrev_b32 v108, 16, v32
  v_and_b32 v109, s90, v32
  v_lshlrev_b32 v110, 16, v33
  v_and_b32 v111, s90, v33
  s_waitcnt lgkmcnt(4)
  v_mfma_f32_32x32x16_bf16 v[64:79], v[36:39], v[132:135], v[64:79]
  ds_read_b64_tr_b16 v[48:49], v10 offset:5120
  ds_read_b64_tr_b16 v[50:51], v10 offset:5376
  v_lshlrev_b32 v112, 16, v34
  v_and_b32 v113, s90, v34
  v_lshlrev_b32 v114, 16, v35
  v_and_b32 v115, s90, v35
  s_waitcnt lgkmcnt(4)
  v_mfma_f32_32x32x16_bf16 v[64:79], v[40:43], v[136:139], v[64:79]
  ds_read_b64_tr_b16 v[52:53], v11 offset:5120
  ds_read_b64_tr_b16 v[54:55], v11 offset:5376
  v_add_f32 v20, v20, v108
  v_add_f32 v21, v21, v109
  v_add_f32 v20, v20, v110
  v_add_f32 v21, v21, v111
  s_waitcnt lgkmcnt(4)
  v_mfma_f32_32x32x16_bf16 v[64:79], v[44:47], v[140:143], v[64:79]
  ds_read_b64_tr_b16 v[56:57], v12 offset:5120
  ds_read_b64_tr_b16 v[58:59], v12 offset:5376
  v_add_f32 v20, v20, v112
  v_add_f32 v21, v21, v113
  v_add_f32 v20, v20, v114
  v_add_f32 v21, v21, v115
  s_waitcnt lgkmcnt(4)
  v_mfma_f32_32x32x16_bf16 v[64:79], v[48:51], v[144:147], v[64:79]
  ds_read_b64_tr_b16 v[60:61], v13 offset:5120
  ds_read_b64_tr_b16 v[62:63], v13 offset:5376
  v_lshlrev_b32 v108, 16, v48
  v_and_b32 v109, s90, v48
  v_lshlrev_b32 v110, 16, v49
  v_and_b32 v111, s90, v49
  s_waitcnt lgkmcnt(4)
  v_mfma_f32_32x32x16_bf16 v[64:79], v[52:55], v[148:151], v[64:79]
  s_waitcnt vmcnt(7)
  s_barrier
  ds_read_b64_tr_b16 v[32:33], v10 offset:8192
  ds_read_b64_tr_b16 v[34:35], v10 offset:8448
  v_lshlrev_b32 v112, 16, v50
  v_and_b32 v113, s90, v50
  v_lshlrev_b32 v114, 16, v51
  v_and_b32 v115, s90, v51
  s_waitcnt lgkmcnt(4)
  v_mfma_f32_32x32x16_bf16 v[64:79], v[56:59], v[152:155], v[64:79]
  ds_read_b64_tr_b16 v[36:37], v11 offset:8192
  ds_read_b64_tr_b16 v[38:39], v11 offset:8448
  v_add_f32 v20, v20, v108
  v_add_f32 v21, v21, v109
  v_add_f32 v20, v20, v110
  v_add_f32 v21, v21, v111
  s_waitcnt lgkmcnt(4)
  v_mfma_f32_32x32x16_bf16 v[64:79], v[60:63], v[156:159], v[64:79]
  ds_read_b64_tr_b16 v[40:41], v12 offset:8192
  ds_read_b64_tr_b16 v[42:43], v12 offset:8448
  v_add_f32 v20, v20, v112
  v_add_f32 v21, v21, v113
  v_add_f32 v20, v20, v114
  v_add_f32 v21, v21, v115
  s_waitcnt lgkmcnt(4)
  v_mfma_f32_32x32x16_bf16 v[64:79], v[32:35], v[160:163], v[64:79]
  ds_read_b64_tr_b16 v[44:45], v13 offset:8192
  ds_read_b64_tr_b16 v[46:47], v13 offset:8448
  v_lshlrev_b32 v108, 16, v32
  v_and_b32 v109, s90, v32
  v_lshlrev_b32 v110, 16, v33
  v_and_b32 v111, s90, v33
  s_waitcnt lgkmcnt(4)
  v_mfma_f32_32x32x16_bf16 v[64:79], v[36:39], v[164:167], v[64:79]
  ds_read_b64_tr_b16 v[48:49], v10 offset:11264
  ds_read_b64_tr_b16 v[50:51], v10 offset:11520
  v_lshlrev_b32 v112, 16, v34
  v_and_b32 v113, s90, v34
  v_lshlrev_b32 v114, 16, v35
  v_and_b32 v115, s90, v35
  s_waitcnt lgkmcnt(4)
  v_mfma_f32_32x32x16_bf16 v[64:79], v[40:43], v[168:171], v[64:79]
  ds_read_b64_tr_b16 v[52:53], v11 offset:11264
  ds_read_b64_tr_b16 v[54:55], v11 offset:11520
  v_add_f32 v20, v20, v108
  v_add_f32 v21, v21, v109
  v_add_f32 v20, v20, v110
  v_add_f32 v21, v21, v111
  s_waitcnt lgkmcnt(4)
  v_mfma_f32_32x32x16_bf16 v[64:79], v[44:47], v[172:175], v[64:79]
  ds_read_b64_tr_b16 v[56:57], v12 offset:11264
  ds_read_b64_tr_b16 v[58:59], v12 offset:11520
  v_add_f32 v20, v20, v112
  v_add_f32 v21, v21, v113
  v_add_f32 v20, v20, v114
  v_add_f32 v21, v21, v115
  s_waitcnt lgkmcnt(4)
  v_mfma_f32_32x32x16_bf16 v[64:79], v[48:51], v[176:179], v[64:79]
  ds_read_b64_tr_b16 v[60:61], v13 offset:11264
  ds_read_b64_tr_b16 v[62:63], v13 offset:11520
  v_lshlrev_b32 v108, 16, v48
  v_and_b32 v109, s90, v48
  v_lshlrev_b32 v110, 16, v49
  v_and_b32 v111, s90, v49
  s_waitcnt lgkmcnt(4)
  v_mfma_f32_32x32x16_bf16 v[64:79], v[52:55], v[180:183], v[64:79]
  ds_read_b64_tr_b16 v[32:33], v10 offset:14336
  ds_read_b64_tr_b16 v[34:35], v10 offset:14592
  v_lshlrev_b32 v112, 16, v50
  v_and_b32 v113, s90, v50
  v_lshlrev_b32 v114, 16, v51
  v_and_b32 v115, s90, v51
  s_waitcnt lgkmcnt(4)
  v_mfma_f32_32x32x16_bf16 v[64:79], v[56:59], v[184:187], v[64:79]
  ds_read_b64_tr_b16 v[36:37], v11 offset:14336
  ds_read_b64_tr_b16 v[38:39], v11 offset:14592
  v_add_f32 v20, v20, v108
  v_add_f32 v21, v21, v109
  v_add_f32 v20, v20, v110
  v_add_f32 v21, v21, v111
  s_waitcnt lgkmcnt(4)
  v_mfma_f32_32x32x16_bf16 v[64:79], v[60:63], v[188:191], v[64:79]
  ds_read_b64_tr_b16 v[40:41], v12 offset:14336
  ds_read_b64_tr_b16 v[42:43], v12 offset:14592
  v_add_f32 v20, v20, v112
  v_add_f32 v21, v21, v113
  v_add_f32 v20, v20, v114
  v_add_f32 v21, v21, v115
  s_waitcnt lgkmcnt(4)
  v_mfma_f32_32x32x16_bf16 v[64:79], v[32:35], v[192:195], v[64:79]
  ds_read_b64_tr_b16 v[44:45], v13 offset:14336
  ds_read_b64_tr_b16 v[46:47], v13 offset:14592
  v_lshlrev_b32 v108, 16, v32
  v_and_b32 v109, s90, v32
  v_lshlrev_b32 v110, 16, v33
  v_and_b32 v111, s90, v33
  s_waitcnt lgkmcnt(4)
  v_mfma_f32_32x32x16_bf16 v[64:79], v[36:39], v[196:199], v[64:79]
  s_waitcnt vmcnt(5)
  s_barrier
  ds_read_b64_tr_b16 v[48:49], v10 offset:20480
  ds_read_b64_tr_b16 v[50:51], v10 offset:20736
  v_lshlrev_b32 v112, 16, v34
  v_and_b32 v113, s90, v34
  v_lshlrev_b32 v114, 16, v35
  v_and_b32 v115, s90, v35
  s_waitcnt lgkmcnt(4)
  v_mfma_f32_32x32x16_bf16 v[64:79], v[40:43], v[200:203], v[64:79]
  ds_read_b64_tr_b16 v[52:53], v10 offset:17408
  ds_read_b64_tr_b16 v[54:55], v10 offset:17664
  v_add_f32 v20, v20, v108
  v_add_f32 v21, v21, v109
  v_add_f32 v20, v20, v110
  v_add_f32 v21, v21, v111
  s_waitcnt vmcnt(0)
  s_mov_b64 exec, 1
  buffer_store_dword v30, v31, s[16:19], s83 offen sc1
  s_mov_b64 exec, -1
  s_waitcnt lgkmcnt(4)
  v_mfma_f32_32x32x16_bf16 v[64:79], v[44:47], v[204:207], v[64:79]
  ds_read_b64_tr_b16 v[56:57], v11 offset:17408
  ds_read_b64_tr_b16 v[58:59], v11 offset:17664
  v_add_f32 v20, v20, v112
  v_add_f32 v21, v21, v113
  v_add_f32 v20, v20, v114
  v_add_f32 v21, v21, v115
  s_waitcnt lgkmcnt(4)
  v_mfma_f32_32x32x16_bf16 v[64:79], v[48:51], v[224:227], v[64:79]
  ds_read_b64_tr_b16 v[60:61], v12 offset:17408
  ds_read_b64_tr_b16 v[62:63], v12 offset:17664
  v_lshlrev_b32 v108, 16, v48
  v_and_b32 v109, s90, v48
  v_lshlrev_b32 v110, 16, v49
  v_and_b32 v111, s90, v49
  v_lshlrev_b32 v112, 16, v50
  v_and_b32 v113, s90, v50
  v_lshlrev_b32 v114, 16, v51
  v_and_b32 v115, s90, v51
  s_waitcnt lgkmcnt(4)
  v_mfma_f32_32x32x16_bf16 v[64:79], v[52:55], v[208:211], v[64:79]
  ds_read_b64_tr_b16 v[32:33], v13 offset:17408
  ds_read_b64_tr_b16 v[34:35], v13 offset:17664
  v_lshlrev_b32 v116, 16, v52
  v_and_b32 v117, s90, v52
  v_lshlrev_b32 v118, 16, v53
  v_and_b32 v119, s90, v53
  v_lshlrev_b32 v120, 16, v54
  v_and_b32 v121, s90, v54
  v_lshlrev_b32 v122, 16, v55
  v_and_b32 v123, s90, v55
  s_waitcnt lgkmcnt(4)
  v_mfma_f32_32x32x16_bf16 v[64:79], v[56:59], v[212:215], v[64:79]
  ds_read_b64_tr_b16 v[36:37], v11 offset:20480
  ds_read_b64_tr_b16 v[38:39], v11 offset:20736
  v_add_f32 v20, v20, v108
  v_add_f32 v21, v21, v109
  v_add_f32 v20, v20, v110
  v_add_f32 v21, v21, v111
  v_add_f32 v20, v20, v112
  v_add_f32 v21, v21, v113
  v_add_f32 v20, v20, v114
  v_add_f32 v21, v21, v115
  v_add_f32 v20, v20, v116
  v_add_f32 v21, v21, v117
  v_add_f32 v20, v20, v118
  v_add_f32 v21, v21, v119
  v_add_f32 v20, v20, v120
  v_add_f32 v21, v21, v121
  v_add_f32 v20, v20, v122
  v_add_f32 v21, v21, v123
  v_add_f32 v20, v20, v21
  ds_write_b32 v24, v20 offset:2048
  s_waitcnt lgkmcnt(5)
  v_mfma_f32_32x32x16_bf16 v[64:79], v[60:63], v[216:219], v[64:79]
  ds_read_b64_tr_b16 v[40:41], v12 offset:20480
  ds_read_b64_tr_b16 v[42:43], v12 offset:20736
  v_mul_f32 v28, 0x3e8b97f6, v28
  s_waitcnt lgkmcnt(2)
  s_barrier
  ds_read_b128 v[108:111], v23 offset:2048
  ds_read_b128 v[112:115], v23 offset:2064
  s_waitcnt lgkmcnt(7)
  v_mfma_f32_32x32x16_bf16 v[64:79], v[32:35], v[220:223], v[64:79]
  ds_read_b64_tr_b16 v[44:45], v13 offset:20480
  ds_read_b64_tr_b16 v[46:47], v13 offset:20736
  s_waitcnt lgkmcnt(7)
  v_mfma_f32_32x32x16_bf16 v[64:79], v[36:39], v[228:231], v[64:79]
  s_waitcnt lgkmcnt(2)
  v_add_f32 v108, v108, v109
  v_add_f32 v110, v110, v111
  v_add_f32 v112, v112, v113
  v_add_f32 v114, v114, v115
  v_add_f32 v108, v108, v110
  v_add_f32 v112, v112, v114
  s_waitcnt lgkmcnt(4)
  v_mfma_f32_32x32x16_bf16 v[64:79], v[40:43], v[232:235], v[64:79]
  v_add_f32 v108, v108, v112
  v_cvt_pk_bf16_f32 v22, -v108, -v108
  v_and_b32 v22, 0xffff0000, v22
  v_sub_f32_e64 v104, -v108, v22
  v_cvt_pk_bf16_f32 v104, v22, v104
  s_waitcnt lgkmcnt(0)
  v_mfma_f32_32x32x16_bf16 v[64:79], v[44:47], v[236:239], v[64:79]
  v_mfma_f32_32x32x16_bf16 v[64:79], v[104:107], v[96:99], v[64:79]
  buffer_load_dwordx4 v[224:227], v1, s[16:19], s65 offen offset:0 sc1
  buffer_load_dwordx4 v[228:231], v1, s[16:19], s65 offen offset:1024 sc1
  buffer_load_dwordx4 v[232:235], v1, s[16:19], s65 offen offset:2048 sc1
  buffer_load_dwordx4 v[236:239], v1, s[16:19], s65 offen offset:3072 sc1
  buffer_load_dword v15, v6, s[16:19], s65 offen sc1
  s_nop 6
  v_pk_mul_f32 v[64:65], v[64:65], v[28:29] op_sel_hi:[1,0]
  v_pk_mul_f32 v[66:67], v[66:67], v[28:29] op_sel_hi:[1,0]
  v_pk_mul_f32 v[68:69], v[68:69], v[28:29] op_sel_hi:[1,0]
  v_pk_mul_f32 v[70:71], v[70:71], v[28:29] op_sel_hi:[1,0]
  v_pk_mul_f32 v[72:73], v[72:73], v[28:29] op_sel_hi:[1,0]
  v_pk_mul_f32 v[74:75], v[74:75], v[28:29] op_sel_hi:[1,0]
  v_pk_mul_f32 v[76:77], v[76:77], v[28:29] op_sel_hi:[1,0]
  v_pk_mul_f32 v[78:79], v[78:79], v[28:29] op_sel_hi:[1,0]
  v_cvt_pk_bf16_f32 v152, v64, v65
  v_cvt_pk_bf16_f32 v153, v66, v67
  v_cvt_pk_bf16_f32 v154, v68, v69
  v_cvt_pk_bf16_f32 v155, v70, v71
  v_cvt_pk_bf16_f32 v156, v72, v73
  v_cvt_pk_bf16_f32 v157, v74, v75
  v_mfma_f32_32x32x16_bf16 v[32:47], v[240:243], v[152:155], 0
  v_cvt_pk_bf16_f32 v158, v76, v77
  v_cvt_pk_bf16_f32 v159, v78, v79
  v_cndmask_b32 v158, 0, v158, s[86:87]
  v_cndmask_b32 v159, 0, v159, s[86:87]
  s_nop 1
  v_mfma_f32_32x32x16_bf16 v[48:63], v[244:247], v[156:159], v[32:47]
  ds_write_b128 v127, v[152:155]
  v_and_b32 v2, 15, v0
  v_lshlrev_b32 v2, 2, v2
  s_mov_b32 s92, 0x00010001
  s_lshl_b32 s92, s92, s46
  s_mov_b32 s93, s92
  s_nop 5
  v_max3_f32 v22, v48, v49, v50
  v_max3_f32 v23, v51, v52, v53
  v_max3_f32 v22, v22, v54, v55
  v_max3_f32 v23, v23, v56, v57
  v_max3_f32 v22, v22, v58, v59
  v_max3_f32 v23, v23, v60, v61
  v_max3_f32 v22, v22, v62, v63
  v_max_f32 v22, v22, v23
  v_mov_b32 v23, v22
  s_nop 1
  v_permlane32_swap_b32 v22, v23
  v_max_f32 v22, v22, v23
  v_cvt_pk_bf16_f32 v23, -v22, -v22
  v_and_b32 v23, 0xffff0000, v23
  v_sub_f32_e64 v24, -v22, v23
  v_cvt_pk_bf16_f32 v25, v24, v24
  v_and_b32 v25, 0xffff0000, v25
  v_sub_f32 v24, v24, v25
  v_cvt_pk_bf16_f32 v23, v23, v25
  v_cvt_pk_bf16_f32 v24, v24, 0
  v_cndmask_b32 v158, v23, v158, s[86:87]
  v_cndmask_b32 v159, v24, v159, s[86:87]
  ds_write_b128 v127, v[156:159] offset:1024
  s_nop 0
  v_mfma_f32_32x32x16_bf16 v[32:47], v[244:247], v[156:159], v[32:47]
  s_waitcnt lgkmcnt(0)
  s_barrier
  ds_read_b128 v[128:131], v124
  ds_read_b128 v[132:135], v124 offset:1024
  ds_read_b128 v[136:139], v125
  ds_read_b128 v[140:143], v125 offset:1024
  ds_read_b128 v[144:147], v126
  ds_read_b128 v[148:151], v126 offset:1024
L_att:
  s_nop 3
  v_exp_f32 v64, v32
  v_exp_f32 v65, v33
  v_exp_f32 v66, v34
  v_exp_f32 v67, v35
  s_waitcnt lgkmcnt(4)
  v_mfma_f32_32x32x16_bf16 v[48:63], v[240:243], v[128:131], 0
  v_exp_f32 v68, v36
  v_exp_f32 v69, v37
  v_cvt_pk_bf16_f32 v72, v64, v65
  v_cvt_pk_bf16_f32 v73, v66, v67
  v_exp_f32 v70, v38
  v_exp_f32 v71, v39
  v_mfma_f32_32x32x16_bf16 v[48:63], v[244:247], v[132:135], v[48:63]
  v_exp_f32 v64, v40
  v_exp_f32 v65, v41
  v_cvt_pk_bf16_f32 v74, v68, v69
  v_cvt_pk_bf16_f32 v75, v70, v71
  v_exp_f32 v66, v42
  v_exp_f32 v67, v43
  v_mfma_f32_32x32x16_bf16 v[208:223], v[248:251], v[72:75], 0
  v_exp_f32 v68, v44
  v_exp_f32 v69, v45
  v_cvt_pk_bf16_f32 v76, v64, v65
  v_cvt_pk_bf16_f32 v77, v66, v67
  v_exp_f32 v70, v46
  v_exp_f32 v71, v47
  s_waitcnt lgkmcnt(0)
  v_mfma_f32_32x32x16_bf16 v[32:47], v[240:243], v[136:139], 0
  v_exp_f32 v64, v48
  v_exp_f32 v65, v49
  v_cvt_pk_bf16_f32 v78, v68, v69
  v_cvt_pk_bf16_f32 v79, v70, v71
  v_exp_f32 v66, v50
  v_exp_f32 v67, v51
  v_mfma_f32_32x32x16_bf16 v[208:223], v[252:255], v[76:79], v[208:223]
  buffer_load_dword v3, v2, s[16:19], s82 offen sc1
  v_exp_f32 v68, v52
  v_exp_f32 v69, v53
  v_cvt_pk_bf16_f32 v72, v64, v65
  v_cvt_pk_bf16_f32 v73, v66, v67
  v_exp_f32 v70, v54
  v_exp_f32 v71, v55
  v_mfma_f32_32x32x16_bf16 v[32:47], v[244:247], v[140:143], v[32:47]
  v_exp_f32 v64, v56
  v_exp_f32 v65, v57
  v_cvt_pk_bf16_f32 v74, v68, v69
  v_cvt_pk_bf16_f32 v75, v70, v71
  v_exp_f32 v66, v58
  v_exp_f32 v67, v59
  v_mfma_f32_32x32x16_bf16 v[160:175], v[248:251], v[72:75], 0
  v_exp_f32 v68, v60
  v_exp_f32 v69, v61
  v_cvt_pk_bf16_f32 v76, v64, v65
  v_cvt_pk_bf16_f32 v77, v66, v67
  v_exp_f32 v70, v62
  v_exp_f32 v71, v63
  v_mfma_f32_32x32x16_bf16 v[48:63], v[240:243], v[144:147], 0
  v_exp_f32 v64, v32
  v_exp_f32 v65, v33
  v_cvt_pk_bf16_f32 v78, v68, v69
  v_cvt_pk_bf16_f32 v79, v70, v71
  v_exp_f32 v66, v34
  v_exp_f32 v67, v35
  v_mfma_f32_32x32x16_bf16 v[160:175], v[252:255], v[76:79], v[160:175]
  v_exp_f32 v68, v36
  v_exp_f32 v69, v37
  v_cvt_pk_bf16_f32 v72, v64, v65
  v_cvt_pk_bf16_f32 v73, v66, v67
  v_exp_f32 v70, v38
  v_exp_f32 v71, v39
  v_mfma_f32_32x32x16_bf16 v[48:63], v[244:247], v[148:151], v[48:63]
  v_exp_f32 v64, v40
  v_exp_f32 v65, v41
  v_cvt_pk_bf16_f32 v74, v68, v69
  v_cvt_pk_bf16_f32 v75, v70, v71
  v_exp_f32 v66, v42
  v_exp_f32 v67, v43
  v_mfma_f32_32x32x16_bf16 v[176:191], v[248:251], v[72:75], 0
  v_exp_f32 v68, v44
  v_exp_f32 v69, v45
  v_cvt_pk_bf16_f32 v76, v64, v65
  v_cvt_pk_bf16_f32 v77, v66, v67
  v_exp_f32 v70, v46
  v_exp_f32 v71, v47
  s_waitcnt vmcnt(1)
L_kvc1:
  v_add3_u32 v7, v224, v225, v30
  v_add3_u32 v7, v226, v227, v7
  v_add3_u32 v7, v228, v229, v7
  v_add3_u32 v7, v230, v231, v7
  v_add3_u32 v7, v232, v233, v7
  v_add3_u32 v7, v234, v235, v7
  v_add3_u32 v7, v236, v237, v7
  v_add3_u32 v7, v238, v239, v7
  v_cmp_ne_u32 vcc, v7, v15
  s_cbranch_vccnz L_kvr1
L_kvd1:
  s_waitcnt vmcnt(0)
L_kvpoll:
  v_cmp_ne_u32 vcc, s49, v3
  s_andn2_b64 vcc, vcc, s[92:93]
  s_cbranch_vccnz L_kvpr
L_kvok:
  v_mfma_f32_32x32x16_bf16 v[32:47], v[224:227], v[128:131], 0
  buffer_load_dwordx4 v[80:83], v1, s[16:19], s66 offen offset:0 sc1
  buffer_load_dwordx4 v[84:87], v1, s[16:19], s66 offen offset:1024 sc1
  v_exp_f32 v64, v48
  v_exp_f32 v65, v49
  v_cvt_pk_bf16_f32 v78, v68, v69
  v_cvt_pk_bf16_f32 v79, v70, v71
  v_exp_f32 v66, v50
  v_exp_f32 v67, v51
  v_mfma_f32_32x32x16_bf16 v[176:191], v[252:255], v[76:79], v[176:191]
  buffer_load_dwordx4 v[88:91], v1, s[16:19], s66 offen offset:2048 sc1
  buffer_load_dwordx4 v[92:95], v1, s[16:19], s66 offen offset:3072 sc1
  v_exp_f32 v68, v52
  v_exp_f32 v69, v53
  v_cvt_pk_bf16_f32 v72, v64, v65
  v_cvt_pk_bf16_f32 v73, v66, v67
  v_exp_f32 v70, v54
  v_exp_f32 v71, v55
  v_mfma_f32_32x32x16_bf16 v[32:47], v[228:231], v[132:135], v[32:47]
  buffer_load_dwordx4 v[96:99], v1, s[16:19], s67 offen offset:0 sc1
  buffer_load_dwordx4 v[100:103], v1, s[16:19], s67 offen offset:1024 sc1
  v_exp_f32 v64, v56
  v_exp_f32 v65, v57
  v_cvt_pk_bf16_f32 v74, v68, v69
  v_cvt_pk_bf16_f32 v75, v70, v71
  v_exp_f32 v66, v58
  v_exp_f32 v67, v59
  v_mfma_f32_32x32x16_bf16 v[192:207], v[248:251], v[72:75], 0
  buffer_load_dwordx4 v[104:107], v1, s[16:19], s67 offen offset:2048 sc1
  buffer_load_dwordx4 v[108:111], v1, s[16:19], s67 offen offset:3072 sc1
  v_exp_f32 v68, v60
  v_exp_f32 v69, v61
  v_cvt_pk_bf16_f32 v76, v64, v65
  v_cvt_pk_bf16_f32 v77, v66, v67
  v_exp_f32 v70, v62
  v_exp_f32 v71, v63
  s_barrier
  v_mfma_f32_32x32x16_bf16 v[48:63], v[224:227], v[136:139], 0
  v_exp_f32 v64, v32
  v_exp_f32 v65, v33
  v_cvt_pk_bf16_f32 v78, v68, v69
  v_cvt_pk_bf16_f32 v79, v70, v71
  v_exp_f32 v66, v34
  v_exp_f32 v67, v35
  v_mfma_f32_32x32x16_bf16 v[192:207], v[252:255], v[76:79], v[192:207]
  v_exp_f32 v68, v36
  v_exp_f32 v69, v37
  v_cvt_pk_bf16_f32 v72, v64, v65
  v_cvt_pk_bf16_f32 v73, v66, v67
  v_exp_f32 v70, v38
  v_exp_f32 v71, v39
  v_mfma_f32_32x32x16_bf16 v[48:63], v[228:231], v[140:143], v[48:63]
  buffer_load_dwordx4 v[240:243], v1, s[16:19], s68 offen offset:0 sc1
  v_exp_f32 v64, v40
  v_exp_f32 v65, v41
  v_cvt_pk_bf16_f32 v74, v68, v69
  v_cvt_pk_bf16_f32 v75, v70, v71
  v_exp_f32 v66, v42
  v_exp_f32 v67, v43
  v_mfma_f32_32x32x16_bf16 v[160:175], v[232:235], v[72:75], v[160:175]
  v_exp_f32 v68, v44
  v_exp_f32 v69, v45
  v_cvt_pk_bf16_f32 v76, v64, v65
  v_cvt_pk_bf16_f32 v77, v66, v67
  v_exp_f32 v70, v46
  v_exp_f32 v71, v47
  v_mfma_f32_32x32x16_bf16 v[32:47], v[224:227], v[144:147], 0
  v_exp_f32 v64, v48
  v_exp_f32 v65, v49
  v_cvt_pk_bf16_f32 v78, v68, v69
  v_cvt_pk_bf16_f32 v79, v70, v71
  v_exp_f32 v66, v50
  v_exp_f32 v67, v51
  v_mfma_f32_32x32x16_bf16 v[160:175], v[236:239], v[76:79], v[160:175]
  v_exp_f32 v68, v52
  v_exp_f32 v69, v53
  v_cvt_pk_bf16_f32 v72, v64, v65
  v_cvt_pk_bf16_f32 v73, v66, v67
  v_exp_f32 v70, v54
  v_exp_f32 v71, v55
  v_mfma_f32_32x32x16_bf16 v[32:47], v[228:231], v[148:151], v[32:47]
  buffer_load_dwordx4 v[244:247], v1, s[16:19], s68 offen offset:1024 sc1
  v_exp_f32 v64, v56
  v_exp_f32 v65, v57
  v_cvt_pk_bf16_f32 v74, v68, v69
  v_cvt_pk_bf16_f32 v75, v70, v71
  v_exp_f32 v66, v58
  v_exp_f32 v67, v59
  v_mfma_f32_32x32x16_bf16 v[176:191], v[232:235], v[72:75], v[176:191]
  v_exp_f32 v68, v60
  v_exp_f32 v69, v61
  v_cvt_pk_bf16_f32 v76, v64, v65
  v_cvt_pk_bf16_f32 v77, v66, v67
  v_exp_f32 v70, v62
  v_exp_f32 v71, v63
  v_mfma_f32_32x32x16_bf16 v[48:63], v[224:227], v[152:155], 0
  v_exp_f32 v64, v32
  v_exp_f32 v65, v33
  v_cvt_pk_bf16_f32 v78, v68, v69
  v_cvt_pk_bf16_f32 v79, v70, v71
  v_exp_f32 v66, v34
  v_exp_f32 v67, v35
  v_mfma_f32_32x32x16_bf16 v[176:191], v[236:239], v[76:79], v[176:191]
  v_exp_f32 v68, v36
  v_exp_f32 v69, v37
  v_cvt_pk_bf16_f32 v72, v64, v65
  v_cvt_pk_bf16_f32 v73, v66, v67
  v_exp_f32 v70, v38
  v_exp_f32 v71, v39
  v_mfma_f32_32x32x16_bf16 v[48:63], v[228:231], v[156:159], v[48:63]
  buffer_load_dwordx4 v[248:251], v1, s[16:19], s68 offen offset:2048 sc1
  v_exp_f32 v64, v40
  v_exp_f32 v65, v41
  v_cvt_pk_bf16_f32 v74, v68, v69
  v_cvt_pk_bf16_f32 v75, v70, v71
  v_exp_f32 v66, v42
  v_exp_f32 v67, v43
  v_mfma_f32_32x32x16_bf16 v[192:207], v[232:235], v[72:75], v[192:207]
  v_exp_f32 v68, v44
  v_exp_f32 v69, v45
  v_cvt_pk_bf16_f32 v76, v64, v65
  v_cvt_pk_bf16_f32 v77, v66, v67
  v_exp_f32 v70, v46
  v_exp_f32 v71, v47
  s_waitcnt vmcnt(7)
  v_mfma_f32_32x32x16_bf16 v[32:47], v[80:83], v[128:131], 0
  v_exp_f32 v64, v48
  v_exp_f32 v65, v49
  v_cvt_pk_bf16_f32 v78, v68, v69
  v_cvt_pk_bf16_f32 v79, v70, v71
  v_exp_f32 v66, v50
  v_exp_f32 v67, v51
  v_mfma_f32_32x32x16_bf16 v[192:207], v[236:239], v[76:79], v[192:207]
  v_exp_f32 v68, v52
  v_exp_f32 v69, v53
  v_cvt_pk_bf16_f32 v72, v64, v65
  v_cvt_pk_bf16_f32 v73, v66, v67
  v_exp_f32 v70, v54
  v_exp_f32 v71, v55
  v_mfma_f32_32x32x16_bf16 v[32:47], v[84:87], v[132:135], v[32:47]
  buffer_load_dwordx4 v[252:255], v1, s[16:19], s68 offen offset:3072 sc1
  v_exp_f32 v64, v56
  v_exp_f32 v65, v57
  v_cvt_pk_bf16_f32 v74, v68, v69
  v_cvt_pk_bf16_f32 v75, v70, v71
  v_exp_f32 v66, v58
  v_exp_f32 v67, v59
  v_mfma_f32_32x32x16_bf16 v[208:223], v[232:235], v[72:75], v[208:223]
  v_exp_f32 v68, v60
  v_exp_f32 v69, v61
  v_cvt_pk_bf16_f32 v76, v64, v65
  v_cvt_pk_bf16_f32 v77, v66, v67
  v_exp_f32 v70, v62
  v_exp_f32 v71, v63
  v_mfma_f32_32x32x16_bf16 v[48:63], v[80:83], v[136:139], 0
  v_exp_f32 v64, v32
  v_exp_f32 v65, v33
  v_cvt_pk_bf16_f32 v78, v68, v69
  v_cvt_pk_bf16_f32 v79, v70, v71
  v_exp_f32 v66, v34
  v_exp_f32 v67, v35
  v_mfma_f32_32x32x16_bf16 v[208:223], v[236:239], v[76:79], v[208:223]
  v_exp_f32 v68, v36
  v_exp_f32 v69, v37
  v_cvt_pk_bf16_f32 v72, v64, v65
  v_cvt_pk_bf16_f32 v73, v66, v67
  v_exp_f32 v70, v38
  v_exp_f32 v71, v39
  v_mfma_f32_32x32x16_bf16 v[48:63], v[84:87], v[140:143], v[48:63]
  buffer_load_dwordx4 v[224:227], v1, s[16:19], s69 offen offset:0 sc1
  v_exp_f32 v64, v40
  v_exp_f32 v65, v41
  v_cvt_pk_bf16_f32 v74, v68, v69
  v_cvt_pk_bf16_f32 v75, v70, v71
  v_exp_f32 v66, v42
  v_exp_f32 v67, v43
  v_mfma_f32_32x32x16_bf16 v[160:175], v[88:91], v[72:75], v[160:175]
  v_exp_f32 v68, v44
  v_exp_f32 v69, v45
  v_cvt_pk_bf16_f32 v76, v64, v65
  v_cvt_pk_bf16_f32 v77, v66, v67
  v_exp_f32 v70, v46
  v_exp_f32 v71, v47
  v_mfma_f32_32x32x16_bf16 v[32:47], v[80:83], v[144:147], 0
  v_exp_f32 v64, v48
  v_exp_f32 v65, v49
  v_cvt_pk_bf16_f32 v78, v68, v69
  v_cvt_pk_bf16_f32 v79, v70, v71
  v_exp_f32 v66, v50
  v_exp_f32 v67, v51
  v_mfma_f32_32x32x16_bf16 v[160:175], v[92:95], v[76:79], v[160:175]
  v_exp_f32 v68, v52
  v_exp_f32 v69, v53
  v_cvt_pk_bf16_f32 v72, v64, v65
  v_cvt_pk_bf16_f32 v73, v66, v67
  v_exp_f32 v70, v54
  v_exp_f32 v71, v55
  v_mfma_f32_32x32x16_bf16 v[32:47], v[84:87], v[148:151], v[32:47]
  buffer_load_dwordx4 v[228:231], v1, s[16:19], s69 offen offset:1024 sc1
  v_exp_f32 v64, v56
  v_exp_f32 v65, v57
  v_cvt_pk_bf16_f32 v74, v68, v69
  v_cvt_pk_bf16_f32 v75, v70, v71
  v_exp_f32 v66, v58
  v_exp_f32 v67, v59
  v_mfma_f32_32x32x16_bf16 v[176:191], v[88:91], v[72:75], v[176:191]
  v_exp_f32 v68, v60
  v_exp_f32 v69, v61
  v_cvt_pk_bf16_f32 v76, v64, v65
  v_cvt_pk_bf16_f32 v77, v66, v67
  v_exp_f32 v70, v62
  v_exp_f32 v71, v63
  v_mfma_f32_32x32x16_bf16 v[48:63], v[80:83], v[152:155], 0
  v_exp_f32 v64, v32
  v_exp_f32 v65, v33
  v_cvt_pk_bf16_f32 v78, v68, v69
  v_cvt_pk_bf16_f32 v79, v70, v71
  v_exp_f32 v66, v34
  v_exp_f32 v67, v35
  v_mfma_f32_32x32x16_bf16 v[176:191], v[92:95], v[76:79], v[176:191]
  v_exp_f32 v68, v36
  v_exp_f32 v69, v37
  v_cvt_pk_bf16_f32 v72, v64, v65
  v_cvt_pk_bf16_f32 v73, v66, v67
  v_exp_f32 v70, v38
  v_exp_f32 v71, v39
  v_mfma_f32_32x32x16_bf16 v[48:63], v[84:87], v[156:159], v[48:63]
  buffer_load_dwordx4 v[232:235], v1, s[16:19], s69 offen offset:2048 sc1
  v_exp_f32 v64, v40
  v_exp_f32 v65, v41
  v_cvt_pk_bf16_f32 v74, v68, v69
  v_cvt_pk_bf16_f32 v75, v70, v71
  v_exp_f32 v66, v42
  v_exp_f32 v67, v43
  v_mfma_f32_32x32x16_bf16 v[192:207], v[88:91], v[72:75], v[192:207]
  v_exp_f32 v68, v44
  v_exp_f32 v69, v45
  v_cvt_pk_bf16_f32 v76, v64, v65
  v_cvt_pk_bf16_f32 v77, v66, v67
  v_exp_f32 v70, v46
  v_exp_f32 v71, v47
  s_waitcnt vmcnt(7)
  v_mfma_f32_32x32x16_bf16 v[32:47], v[96:99], v[128:131], 0
  v_exp_f32 v64, v48
  v_exp_f32 v65, v49
  v_cvt_pk_bf16_f32 v78, v68, v69
  v_cvt_pk_bf16_f32 v79, v70, v71
  v_exp_f32 v66, v50
  v_exp_f32 v67, v51
  v_mfma_f32_32x32x16_bf16 v[192:207], v[92:95], v[76:79], v[192:207]
  v_exp_f32 v68, v52
  v_exp_f32 v69, v53
  v_cvt_pk_bf16_f32 v72, v64, v65
  v_cvt_pk_bf16_f32 v73, v66, v67
  v_exp_f32 v70, v54
  v_exp_f32 v71, v55
  v_mfma_f32_32x32x16_bf16 v[32:47], v[100:103], v[132:135], v[32:47]
  buffer_load_dwordx4 v[236:239], v1, s[16:19], s69 offen offset:3072 sc1
  v_exp_f32 v64, v56
  v_exp_f32 v65, v57
  v_cvt_pk_bf16_f32 v74, v68, v69
  v_cvt_pk_bf16_f32 v75, v70, v71
  v_exp_f32 v66, v58
  v_exp_f32 v67, v59
  v_mfma_f32_32x32x16_bf16 v[208:223], v[88:91], v[72:75], v[208:223]
  v_exp_f32 v68, v60
  v_exp_f32 v69, v61
  v_cvt_pk_bf16_f32 v76, v64, v65
  v_cvt_pk_bf16_f32 v77, v66, v67
  v_exp_f32 v70, v62
  v_exp_f32 v71, v63
  v_mfma_f32_32x32x16_bf16 v[48:63], v[96:99], v[136:139], 0
  v_exp_f32 v64, v32
  v_exp_f32 v65, v33
  v_cvt_pk_bf16_f32 v78, v68, v69
  v_cvt_pk_bf16_f32 v79, v70, v71
  v_exp_f32 v66, v34
  v_exp_f32 v67, v35
  v_mfma_f32_32x32x16_bf16 v[208:223], v[92:95], v[76:79], v[208:223]
  v_exp_f32 v68, v36
  v_exp_f32 v69, v37
  v_cvt_pk_bf16_f32 v72, v64, v65
  v_cvt_pk_bf16_f32 v73, v66, v67
  v_exp_f32 v70, v38
  v_exp_f32 v71, v39
  v_mfma_f32_32x32x16_bf16 v[48:63], v[100:103], v[140:143], v[48:63]
  buffer_load_dwordx4 v[80:83], v1, s[16:19], s70 offen offset:0 sc1
  v_exp_f32 v64, v40
  v_exp_f32 v65, v41
  v_cvt_pk_bf16_f32 v74, v68, v69
  v_cvt_pk_bf16_f32 v75, v70, v71
  v_exp_f32 v66, v42
  v_exp_f32 v67, v43
  v_mfma_f32_32x32x16_bf16 v[160:175], v[104:107], v[72:75], v[160:175]
  v_exp_f32 v68, v44
  v_exp_f32 v69, v45
  v_cvt_pk_bf16_f32 v76, v64, v65
  v_cvt_pk_bf16_f32 v77, v66, v67
  v_exp_f32 v70, v46
  v_exp_f32 v71, v47
  v_mfma_f32_32x32x16_bf16 v[32:47], v[96:99], v[144:147], 0
  v_exp_f32 v64, v48
  v_exp_f32 v65, v49
  v_cvt_pk_bf16_f32 v78, v68, v69
  v_cvt_pk_bf16_f32 v79, v70, v71
  v_exp_f32 v66, v50
  v_exp_f32 v67, v51
  v_mfma_f32_32x32x16_bf16 v[160:175], v[108:111], v[76:79], v[160:175]
  v_exp_f32 v68, v52
  v_exp_f32 v69, v53
  v_cvt_pk_bf16_f32 v72, v64, v65
  v_cvt_pk_bf16_f32 v73, v66, v67
  v_exp_f32 v70, v54
  v_exp_f32 v71, v55
  v_mfma_f32_32x32x16_bf16 v[32:47], v[100:103], v[148:151], v[32:47]
  buffer_load_dwordx4 v[84:87], v1, s[16:19], s70 offen offset:1024 sc1
  v_exp_f32 v64, v56
  v_exp_f32 v65, v57
  v_cvt_pk_bf16_f32 v74, v68, v69
  v_cvt_pk_bf16_f32 v75, v70, v71
  v_exp_f32 v66, v58
  v_exp_f32 v67, v59
  v_mfma_f32_32x32x16_bf16 v[176:191], v[104:107], v[72:75], v[176:191]
  v_exp_f32 v68, v60
  v_exp_f32 v69, v61
  v_cvt_pk_bf16_f32 v76, v64, v65
  v_cvt_pk_bf16_f32 v77, v66, v67
  v_exp_f32 v70, v62
  v_exp_f32 v71, v63
  v_mfma_f32_32x32x16_bf16 v[48:63], v[96:99], v[152:155], 0
  v_exp_f32 v64, v32
  v_exp_f32 v65, v33
  v_cvt_pk_bf16_f32 v78, v68, v69
  v_cvt_pk_bf16_f32 v79, v70, v71
  v_exp_f32 v66, v34
  v_exp_f32 v67, v35
  v_mfma_f32_32x32x16_bf16 v[176:191], v[108:111], v[76:79], v[176:191]
  v_exp_f32 v68, v36
  v_exp_f32 v69, v37
  v_cvt_pk_bf16_f32 v72, v64, v65
  v_cvt_pk_bf16_f32 v73, v66, v67
  v_exp_f32 v70, v38
  v_exp_f32 v71, v39
  v_mfma_f32_32x32x16_bf16 v[48:63], v[100:103], v[156:159], v[48:63]
  buffer_load_dwordx4 v[88:91], v1, s[16:19], s70 offen offset:2048 sc1
  v_exp_f32 v64, v40
  v_exp_f32 v65, v41
  v_cvt_pk_bf16_f32 v74, v68, v69
  v_cvt_pk_bf16_f32 v75, v70, v71
  v_exp_f32 v66, v42
  v_exp_f32 v67, v43
  v_mfma_f32_32x32x16_bf16 v[192:207], v[104:107], v[72:75], v[192:207]
  v_exp_f32 v68, v44
  v_exp_f32 v69, v45
  v_cvt_pk_bf16_f32 v76, v64, v65
  v_cvt_pk_bf16_f32 v77, v66, v67
  v_exp_f32 v70, v46
  v_exp_f32 v71, v47
  s_waitcnt vmcnt(7)
  v_mfma_f32_32x32x16_bf16 v[32:47], v[240:243], v[128:131], 0
  v_exp_f32 v64, v48
  v_exp_f32 v65, v49
  v_cvt_pk_bf16_f32 v78, v68, v69
  v_cvt_pk_bf16_f32 v79, v70, v71
  v_exp_f32 v66, v50
  v_exp_f32 v67, v51
  v_mfma_f32_32x32x16_bf16 v[192:207], v[108:111], v[76:79], v[192:207]
  v_exp_f32 v68, v52
  v_exp_f32 v69, v53
  v_cvt_pk_bf16_f32 v72, v64, v65
  v_cvt_pk_bf16_f32 v73, v66, v67
  v_exp_f32 v70, v54
  v_exp_f32 v71, v55
  v_mfma_f32_32x32x16_bf16 v[32:47], v[244:247], v[132:135], v[32:47]
  buffer_load_dwordx4 v[92:95], v1, s[16:19], s70 offen offset:3072 sc1
  v_exp_f32 v64, v56
  v_exp_f32 v65, v57
  v_cvt_pk_bf16_f32 v74, v68, v69
  v_cvt_pk_bf16_f32 v75, v70, v71
  v_exp_f32 v66, v58
  v_exp_f32 v67, v59
  v_mfma_f32_32x32x16_bf16 v[208:223], v[104:107], v[72:75], v[208:223]
  v_exp_f32 v68, v60
  v_exp_f32 v69, v61
  v_cvt_pk_bf16_f32 v76, v64, v65
  v_cvt_pk_bf16_f32 v77, v66, v67
  v_exp_f32 v70, v62
  v_exp_f32 v71, v63
  v_mfma_f32_32x32x16_bf16 v[48:63], v[240:243], v[136:139], 0
  v_exp_f32 v64, v32
  v_exp_f32 v65, v33
  v_cvt_pk_bf16_f32 v78, v68, v69
  v_cvt_pk_bf16_f32 v79, v70, v71
  v_exp_f32 v66, v34
  v_exp_f32 v67, v35
  v_mfma_f32_32x32x16_bf16 v[208:223], v[108:111], v[76:79], v[208:223]
  v_exp_f32 v68, v36
  v_exp_f32 v69, v37
  v_cvt_pk_bf16_f32 v72, v64, v65
  v_cvt_pk_bf16_f32 v73, v66, v67
  v_exp_f32 v70, v38
  v_exp_f32 v71, v39
  v_mfma_f32_32x32x16_bf16 v[48:63], v[244:247], v[140:143], v[48:63]
  buffer_load_dwordx4 v[96:99], v1, s[16:19], s71 offen offset:0 sc1
  v_exp_f32 v64, v40
  v_exp_f32 v65, v41
  v_cvt_pk_bf16_f32 v74, v68, v69
  v_cvt_pk_bf16_f32 v75, v70, v71
  v_exp_f32 v66, v42
  v_exp_f32 v67, v43
  v_mfma_f32_32x32x16_bf16 v[160:175], v[248:251], v[72:75], v[160:175]
  v_exp_f32 v68, v44
  v_exp_f32 v69, v45
  v_cvt_pk_bf16_f32 v76, v64, v65
  v_cvt_pk_bf16_f32 v77, v66, v67
  v_exp_f32 v70, v46
  v_exp_f32 v71, v47
  v_mfma_f32_32x32x16_bf16 v[32:47], v[240:243], v[144:147], 0
  v_exp_f32 v64, v48
  v_exp_f32 v65, v49
  v_cvt_pk_bf16_f32 v78, v68, v69
  v_cvt_pk_bf16_f32 v79, v70, v71
  v_exp_f32 v66, v50
  v_exp_f32 v67, v51
  v_mfma_f32_32x32x16_bf16 v[160:175], v[252:255], v[76:79], v[160:175]
  v_exp_f32 v68, v52
  v_exp_f32 v69, v53
  v_cvt_pk_bf16_f32 v72, v64, v65
  v_cvt_pk_bf16_f32 v73, v66, v67
  v_exp_f32 v70, v54
  v_exp_f32 v71, v55
  v_mfma_f32_32x32x16_bf16 v[32:47], v[244:247], v[148:151], v[32:47]
  buffer_load_dwordx4 v[100:103], v1, s[16:19], s71 offen offset:1024 sc1
  v_exp_f32 v64, v56
  v_exp_f32 v65, v57
  v_cvt_pk_bf16_f32 v74, v68, v69
  v_cvt_pk_bf16_f32 v75, v70, v71
  v_exp_f32 v66, v58
  v_exp_f32 v67, v59
  v_mfma_f32_32x32x16_bf16 v[176:191], v[248:251], v[72:75], v[176:191]
  v_exp_f32 v68, v60
  v_exp_f32 v69, v61
  v_cvt_pk_bf16_f32 v76, v64, v65
  v_cvt_pk_bf16_f32 v77, v66, v67
  v_exp_f32 v70, v62
  v_exp_f32 v71, v63
  v_mfma_f32_32x32x16_bf16 v[48:63], v[240:243], v[152:155], 0
  v_exp_f32 v64, v32
  v_exp_f32 v65, v33
  v_cvt_pk_bf16_f32 v78, v68, v69
  v_cvt_pk_bf16_f32 v79, v70, v71
  v_exp_f32 v66, v34
  v_exp_f32 v67, v35
  v_mfma_f32_32x32x16_bf16 v[176:191], v[252:255], v[76:79], v[176:191]
  v_exp_f32 v68, v36
  v_exp_f32 v69, v37
  v_cvt_pk_bf16_f32 v72, v64, v65
  v_cvt_pk_bf16_f32 v73, v66, v67
  v_exp_f32 v70, v38
  v_exp_f32 v71, v39
  v_mfma_f32_32x32x16_bf16 v[48:63], v[244:247], v[156:159], v[48:63]
  buffer_load_dwordx4 v[104:107], v1, s[16:19], s71 offen offset:2048 sc1
  v_exp_f32 v64, v40
  v_exp_f32 v65, v41
  v_cvt_pk_bf16_f32 v74, v68, v69
  v_cvt_pk_bf16_f32 v75, v70, v71
  v_exp_f32 v66, v42
  v_exp_f32 v67, v43
  v_mfma_f32_32x32x16_bf16 v[192:207], v[248:251], v[72:75], v[192:207]
  v_exp_f32 v68, v44
  v_exp_f32 v69, v45
  v_cvt_pk_bf16_f32 v76, v64, v65
  v_cvt_pk_bf16_f32 v77, v66, v67
  v_exp_f32 v70, v46
  v_exp_f32 v71, v47
  s_waitcnt vmcnt(7)
  v_mfma_f32_32x32x16_bf16 v[32:47], v[224:227], v[128:131], 0
  v_exp_f32 v64, v48
  v_exp_f32 v65, v49
  v_cvt_pk_bf16_f32 v78, v68, v69
  v_cvt_pk_bf16_f32 v79, v70, v71
  v_exp_f32 v66, v50
  v_exp_f32 v67, v51
  v_mfma_f32_32x32x16_bf16 v[192:207], v[252:255], v[76:79], v[192:207]
  v_exp_f32 v68, v52
  v_exp_f32 v69, v53
  v_cvt_pk_bf16_f32 v72, v64, v65
  v_cvt_pk_bf16_f32 v73, v66, v67
  v_exp_f32 v70, v54
  v_exp_f32 v71, v55
  v_mfma_f32_32x32x16_bf16 v[32:47], v[228:231], v[132:135], v[32:47]
  buffer_load_dwordx4 v[108:111], v1, s[16:19], s71 offen offset:3072 sc1
  v_exp_f32 v64, v56
  v_exp_f32 v65, v57
  v_cvt_pk_bf16_f32 v74, v68, v69
  v_cvt_pk_bf16_f32 v75, v70, v71
  v_exp_f32 v66, v58
  v_exp_f32 v67, v59
  v_mfma_f32_32x32x16_bf16 v[208:223], v[248:251], v[72:75], v[208:223]
  v_exp_f32 v68, v60
  v_exp_f32 v69, v61
  v_cvt_pk_bf16_f32 v76, v64, v65
  v_cvt_pk_bf16_f32 v77, v66, v67
  v_exp_f32 v70, v62
  v_exp_f32 v71, v63
  v_mfma_f32_32x32x16_bf16 v[48:63], v[224:227], v[136:139], 0
  v_exp_f32 v64, v32
  v_exp_f32 v65, v33
  v_cvt_pk_bf16_f32 v78, v68, v69
  v_cvt_pk_bf16_f32 v79, v70, v71
  v_exp_f32 v66, v34
  v_exp_f32 v67, v35
  v_mfma_f32_32x32x16_bf16 v[208:223], v[252:255], v[76:79], v[208:223]
  v_exp_f32 v68, v36
  v_exp_f32 v69, v37
  v_cvt_pk_bf16_f32 v72, v64, v65
  v_cvt_pk_bf16_f32 v73, v66, v67
  v_exp_f32 v70, v38
  v_exp_f32 v71, v39
  v_mfma_f32_32x32x16_bf16 v[48:63], v[228:231], v[140:143], v[48:63]
  buffer_load_dwordx4 v[240:243], v1, s[16:19], s72 offen offset:0 sc1
  v_exp_f32 v64, v40
  v_exp_f32 v65, v41
  v_cvt_pk_bf16_f32 v74, v68, v69
  v_cvt_pk_bf16_f32 v75, v70, v71
  v_exp_f32 v66, v42
  v_exp_f32 v67, v43
  v_mfma_f32_32x32x16_bf16 v[160:175], v[232:235], v[72:75], v[160:175]
  v_exp_f32 v68, v44
  v_exp_f32 v69, v45
  v_cvt_pk_bf16_f32 v76, v64, v65
  v_cvt_pk_bf16_f32 v77, v66, v67
  v_exp_f32 v70, v46
  v_exp_f32 v71, v47
  v_mfma_f32_32x32x16_bf16 v[32:47], v[224:227], v[144:147], 0
  v_exp_f32 v64, v48
  v_exp_f32 v65, v49
  v_cvt_pk_bf16_f32 v78, v68, v69
  v_cvt_pk_bf16_f32 v79, v70, v71
  v_exp_f32 v66, v50
  v_exp_f32 v67, v51
  v_mfma_f32_32x32x16_bf16 v[160:175], v[236:239], v[76:79], v[160:175]
  v_exp_f32 v68, v52
  v_exp_f32 v69, v53
  v_cvt_pk_bf16_f32 v72, v64, v65
  v_cvt_pk_bf16_f32 v73, v66, v67
  v_exp_f32 v70, v54
  v_exp_f32 v71, v55
  v_mfma_f32_32x32x16_bf16 v[32:47], v[228:231], v[148:151], v[32:47]
  buffer_load_dwordx4 v[244:247], v1, s[16:19], s72 offen offset:1024 sc1
  v_exp_f32 v64, v56
  v_exp_f32 v65, v57
  v_cvt_pk_bf16_f32 v74, v68, v69
  v_cvt_pk_bf16_f32 v75, v70, v71
  v_exp_f32 v66, v58
  v_exp_f32 v67, v59
  v_mfma_f32_32x32x16_bf16 v[176:191], v[232:235], v[72:75], v[176:191]
  v_exp_f32 v68, v60
  v_exp_f32 v69, v61
  v_cvt_pk_bf16_f32 v76, v64, v65
  v_cvt_pk_bf16_f32 v77, v66, v67
  v_exp_f32 v70, v62
  v_exp_f32 v71, v63
  v_mfma_f32_32x32x16_bf16 v[48:63], v[224:227], v[152:155], 0
  v_exp_f32 v64, v32
  v_exp_f32 v65, v33
  v_cvt_pk_bf16_f32 v78, v68, v69
  v_cvt_pk_bf16_f32 v79, v70, v71
  v_exp_f32 v66, v34
  v_exp_f32 v67, v35
  v_mfma_f32_32x32x16_bf16 v[176:191], v[236:239], v[76:79], v[176:191]
  v_exp_f32 v68, v36
  v_exp_f32 v69, v37
  v_cvt_pk_bf16_f32 v72, v64, v65
  v_cvt_pk_bf16_f32 v73, v66, v67
  v_exp_f32 v70, v38
  v_exp_f32 v71, v39
  v_mfma_f32_32x32x16_bf16 v[48:63], v[228:231], v[156:159], v[48:63]
  buffer_load_dwordx4 v[248:251], v1, s[16:19], s72 offen offset:2048 sc1
  v_exp_f32 v64, v40
  v_exp_f32 v65, v41
  v_cvt_pk_bf16_f32 v74, v68, v69
  v_cvt_pk_bf16_f32 v75, v70, v71
  v_exp_f32 v66, v42
  v_exp_f32 v67, v43
  v_mfma_f32_32x32x16_bf16 v[192:207], v[232:235], v[72:75], v[192:207]
  v_exp_f32 v68, v44
  v_exp_f32 v69, v45
  v_cvt_pk_bf16_f32 v76, v64, v65
  v_cvt_pk_bf16_f32 v77, v66, v67
  v_exp_f32 v70, v46
  v_exp_f32 v71, v47
  s_waitcnt vmcnt(7)
  v_mfma_f32_32x32x16_bf16 v[32:47], v[80:83], v[128:131], 0
  v_exp_f32 v64, v48
  v_exp_f32 v65, v49
  v_cvt_pk_bf16_f32 v78, v68, v69
  v_cvt_pk_bf16_f32 v79, v70, v71
  v_exp_f32 v66, v50
  v_exp_f32 v67, v51
  v_mfma_f32_32x32x16_bf16 v[192:207], v[236:239], v[76:79], v[192:207]
  v_exp_f32 v68, v52
  v_exp_f32 v69, v53
  v_cvt_pk_bf16_f32 v72, v64, v65
  v_cvt_pk_bf16_f32 v73, v66, v67
  v_exp_f32 v70, v54
  v_exp_f32 v71, v55
  v_mfma_f32_32x32x16_bf16 v[32:47], v[84:87], v[132:135], v[32:47]
  buffer_load_dwordx4 v[252:255], v1, s[16:19], s72 offen offset:3072 sc1
  v_exp_f32 v64, v56
  v_exp_f32 v65, v57
  v_cvt_pk_bf16_f32 v74, v68, v69
  v_cvt_pk_bf16_f32 v75, v70, v71
  v_exp_f32 v66, v58
  v_exp_f32 v67, v59
  v_mfma_f32_32x32x16_bf16 v[208:223], v[232:235], v[72:75], v[208:223]
  v_exp_f32 v68, v60
  v_exp_f32 v69, v61
  v_cvt_pk_bf16_f32 v76, v64, v65
  v_cvt_pk_bf16_f32 v77, v66, v67
  v_exp_f32 v70, v62
  v_exp_f32 v71, v63
  v_mfma_f32_32x32x16_bf16 v[48:63], v[80:83], v[136:139], 0
  v_exp_f32 v64, v32
  v_exp_f32 v65, v33
  v_cvt_pk_bf16_f32 v78, v68, v69
  v_cvt_pk_bf16_f32 v79, v70, v71
  v_exp_f32 v66, v34
  v_exp_f32 v67, v35
  v_mfma_f32_32x32x16_bf16 v[208:223], v[236:239], v[76:79], v[208:223]
  v_exp_f32 v68, v36
  v_exp_f32 v69, v37
  v_cvt_pk_bf16_f32 v72, v64, v65
  v_cvt_pk_bf16_f32 v73, v66, v67
  v_exp_f32 v70, v38
  v_exp_f32 v71, v39
  v_mfma_f32_32x32x16_bf16 v[48:63], v[84:87], v[140:143], v[48:63]
  buffer_load_dwordx4 v[224:227], v1, s[16:19], s73 offen offset:0 sc1
  v_exp_f32 v64, v40
  v_exp_f32 v65, v41
  v_cvt_pk_bf16_f32 v74, v68, v69
  v_cvt_pk_bf16_f32 v75, v70, v71
  v_exp_f32 v66, v42
  v_exp_f32 v67, v43
  v_mfma_f32_32x32x16_bf16 v[160:175], v[88:91], v[72:75], v[160:175]
  v_exp_f32 v68, v44
  v_exp_f32 v69, v45
  v_cvt_pk_bf16_f32 v76, v64, v65
  v_cvt_pk_bf16_f32 v77, v66, v67
  v_exp_f32 v70, v46
  v_exp_f32 v71, v47
  v_mfma_f32_32x32x16_bf16 v[32:47], v[80:83], v[144:147], 0
  v_exp_f32 v64, v48
  v_exp_f32 v65, v49
  v_cvt_pk_bf16_f32 v78, v68, v69
  v_cvt_pk_bf16_f32 v79, v70, v71
  v_exp_f32 v66, v50
  v_exp_f32 v67, v51
  v_mfma_f32_32x32x16_bf16 v[160:175], v[92:95], v[76:79], v[160:175]
  v_exp_f32 v68, v52
  v_exp_f32 v69, v53
  v_cvt_pk_bf16_f32 v72, v64, v65
  v_cvt_pk_bf16_f32 v73, v66, v67
  v_exp_f32 v70, v54
  v_exp_f32 v71, v55
  v_mfma_f32_32x32x16_bf16 v[32:47], v[84:87], v[148:151], v[32:47]
  buffer_load_dwordx4 v[228:231], v1, s[16:19], s73 offen offset:1024 sc1
  v_exp_f32 v64, v56
  v_exp_f32 v65, v57
  v_cvt_pk_bf16_f32 v74, v68, v69
  v_cvt_pk_bf16_f32 v75, v70, v71
  v_exp_f32 v66, v58
  v_exp_f32 v67, v59
  v_mfma_f32_32x32x16_bf16 v[176:191], v[88:91], v[72:75], v[176:191]
  v_exp_f32 v68, v60
  v_exp_f32 v69, v61
  v_cvt_pk_bf16_f32 v76, v64, v65
  v_cvt_pk_bf16_f32 v77, v66, v67
  v_exp_f32 v70, v62
  v_exp_f32 v71, v63
  v_mfma_f32_32x32x16_bf16 v[48:63], v[80:83], v[152:155], 0
  v_exp_f32 v64, v32
  v_exp_f32 v65, v33
  v_cvt_pk_bf16_f32 v78, v68, v69
  v_cvt_pk_bf16_f32 v79, v70, v71
  v_exp_f32 v66, v34
  v_exp_f32 v67, v35
  v_mfma_f32_32x32x16_bf16 v[176:191], v[92:95], v[76:79], v[176:191]
  v_exp_f32 v68, v36
  v_exp_f32 v69, v37
  v_cvt_pk_bf16_f32 v72, v64, v65
  v_cvt_pk_bf16_f32 v73, v66, v67
  v_exp_f32 v70, v38
  v_exp_f32 v71, v39
  v_mfma_f32_32x32x16_bf16 v[48:63], v[84:87], v[156:159], v[48:63]
  buffer_load_dwordx4 v[232:235], v1, s[16:19], s73 offen offset:2048 sc1
  v_exp_f32 v64, v40
  v_exp_f32 v65, v41
  v_cvt_pk_bf16_f32 v74, v68, v69
  v_cvt_pk_bf16_f32 v75, v70, v71
  v_exp_f32 v66, v42
  v_exp_f32 v67, v43
  v_mfma_f32_32x32x16_bf16 v[192:207], v[88:91], v[72:75], v[192:207]
  v_exp_f32 v68, v44
  v_exp_f32 v69, v45
  v_cvt_pk_bf16_f32 v76, v64, v65
  v_cvt_pk_bf16_f32 v77, v66, v67
  v_exp_f32 v70, v46
  v_exp_f32 v71, v47
  s_waitcnt vmcnt(7)
  v_mfma_f32_32x32x16_bf16 v[32:47], v[96:99], v[128:131], 0
  v_exp_f32 v64, v48
  v_exp_f32 v65, v49
  v_cvt_pk_bf16_f32 v78, v68, v69
  v_cvt_pk_bf16_f32 v79, v70, v71
  v_exp_f32 v66, v50
  v_exp_f32 v67, v51
  v_mfma_f32_32x32x16_bf16 v[192:207], v[92:95], v[76:79], v[192:207]
  v_exp_f32 v68, v52
  v_exp_f32 v69, v53
  v_cvt_pk_bf16_f32 v72, v64, v65
  v_cvt_pk_bf16_f32 v73, v66, v67
  v_exp_f32 v70, v54
  v_exp_f32 v71, v55
  v_mfma_f32_32x32x16_bf16 v[32:47], v[100:103], v[132:135], v[32:47]
  buffer_load_dwordx4 v[236:239], v1, s[16:19], s73 offen offset:3072 sc1
  v_exp_f32 v64, v56
  v_exp_f32 v65, v57
  v_cvt_pk_bf16_f32 v74, v68, v69
  v_cvt_pk_bf16_f32 v75, v70, v71
  v_exp_f32 v66, v58
  v_exp_f32 v67, v59
  v_mfma_f32_32x32x16_bf16 v[208:223], v[88:91], v[72:75], v[208:223]
  v_exp_f32 v68, v60
  v_exp_f32 v69, v61
  v_cvt_pk_bf16_f32 v76, v64, v65
  v_cvt_pk_bf16_f32 v77, v66, v67
  v_exp_f32 v70, v62
  v_exp_f32 v71, v63
  v_mfma_f32_32x32x16_bf16 v[48:63], v[96:99], v[136:139], 0
  v_exp_f32 v64, v32
  v_exp_f32 v65, v33
  v_cvt_pk_bf16_f32 v78, v68, v69
  v_cvt_pk_bf16_f32 v79, v70, v71
  v_exp_f32 v66, v34
  v_exp_f32 v67, v35
  v_mfma_f32_32x32x16_bf16 v[208:223], v[92:95], v[76:79], v[208:223]
  v_exp_f32 v68, v36
  v_exp_f32 v69, v37
  v_cvt_pk_bf16_f32 v72, v64, v65
  v_cvt_pk_bf16_f32 v73, v66, v67
  v_exp_f32 v70, v38
  v_exp_f32 v71, v39
  v_mfma_f32_32x32x16_bf16 v[48:63], v[100:103], v[140:143], v[48:63]
  buffer_load_dwordx4 v[80:83], v1, s[16:19], s74 offen offset:0 sc1
  v_exp_f32 v64, v40
  v_exp_f32 v65, v41
  v_cvt_pk_bf16_f32 v74, v68, v69
  v_cvt_pk_bf16_f32 v75, v70, v71
  v_exp_f32 v66, v42
  v_exp_f32 v67, v43
  v_mfma_f32_32x32x16_bf16 v[160:175], v[104:107], v[72:75], v[160:175]
  v_exp_f32 v68, v44
  v_exp_f32 v69, v45
  v_cvt_pk_bf16_f32 v76, v64, v65
  v_cvt_pk_bf16_f32 v77, v66, v67
  v_exp_f32 v70, v46
  v_exp_f32 v71, v47
  v_mfma_f32_32x32x16_bf16 v[32:47], v[96:99], v[144:147], 0
  v_exp_f32 v64, v48
  v_exp_f32 v65, v49
  v_cvt_pk_bf16_f32 v78, v68, v69
  v_cvt_pk_bf16_f32 v79, v70, v71
  v_exp_f32 v66, v50
  v_exp_f32 v67, v51
  v_mfma_f32_32x32x16_bf16 v[160:175], v[108:111], v[76:79], v[160:175]
  v_exp_f32 v68, v52
  v_exp_f32 v69, v53
  v_cvt_pk_bf16_f32 v72, v64, v65
  v_cvt_pk_bf16_f32 v73, v66, v67
  v_exp_f32 v70, v54
  v_exp_f32 v71, v55
  v_mfma_f32_32x32x16_bf16 v[32:47], v[100:103], v[148:151], v[32:47]
  buffer_load_dwordx4 v[84:87], v1, s[16:19], s74 offen offset:1024 sc1
  v_exp_f32 v64, v56
  v_exp_f32 v65, v57
  v_cvt_pk_bf16_f32 v74, v68, v69
  v_cvt_pk_bf16_f32 v75, v70, v71
  v_exp_f32 v66, v58
  v_exp_f32 v67, v59
  v_mfma_f32_32x32x16_bf16 v[176:191], v[104:107], v[72:75], v[176:191]
  v_exp_f32 v68, v60
  v_exp_f32 v69, v61
  v_cvt_pk_bf16_f32 v76, v64, v65
  v_cvt_pk_bf16_f32 v77, v66, v67
  v_exp_f32 v70, v62
  v_exp_f32 v71, v63
  v_mfma_f32_32x32x16_bf16 v[48:63], v[96:99], v[152:155], 0
  v_exp_f32 v64, v32
  v_exp_f32 v65, v33
  v_cvt_pk_bf16_f32 v78, v68, v69
  v_cvt_pk_bf16_f32 v79, v70, v71
  v_exp_f32 v66, v34
  v_exp_f32 v67, v35
  v_mfma_f32_32x32x16_bf16 v[176:191], v[108:111], v[76:79], v[176:191]
  v_exp_f32 v68, v36
  v_exp_f32 v69, v37
  v_cvt_pk_bf16_f32 v72, v64, v65
  v_cvt_pk_bf16_f32 v73, v66, v67
  v_exp_f32 v70, v38
  v_exp_f32 v71, v39
  v_mfma_f32_32x32x16_bf16 v[48:63], v[100:103], v[156:159], v[48:63]
  buffer_load_dwordx4 v[88:91], v1, s[16:19], s74 offen offset:2048 sc1
  v_exp_f32 v64, v40
  v_exp_f32 v65, v41
  v_cvt_pk_bf16_f32 v74, v68, v69
  v_cvt_pk_bf16_f32 v75, v70, v71
  v_exp_f32 v66, v42
  v_exp_f32 v67, v43
  v_mfma_f32_32x32x16_bf16 v[192:207], v[104:107], v[72:75], v[192:207]
  v_exp_f32 v68, v44
  v_exp_f32 v69, v45
  v_cvt_pk_bf16_f32 v76, v64, v65
  v_cvt_pk_bf16_f32 v77, v66, v67
  v_exp_f32 v70, v46
  v_exp_f32 v71, v47
  s_waitcnt vmcnt(7)
  v_mfma_f32_32x32x16_bf16 v[32:47], v[240:243], v[128:131], 0
  v_exp_f32 v64, v48
  v_exp_f32 v65, v49
  v_cvt_pk_bf16_f32 v78, v68, v69
  v_cvt_pk_bf16_f32 v79, v70, v71
  v_exp_f32 v66, v50
  v_exp_f32 v67, v51
  v_mfma_f32_32x32x16_bf16 v[192:207], v[108:111], v[76:79], v[192:207]
  v_exp_f32 v68, v52
  v_exp_f32 v69, v53
  v_cvt_pk_bf16_f32 v72, v64, v65
  v_cvt_pk_bf16_f32 v73, v66, v67
  v_exp_f32 v70, v54
  v_exp_f32 v71, v55
  v_mfma_f32_32x32x16_bf16 v[32:47], v[244:247], v[132:135], v[32:47]
  buffer_load_dwordx4 v[92:95], v1, s[16:19], s74 offen offset:3072 sc1
  v_exp_f32 v64, v56
  v_exp_f32 v65, v57
  v_cvt_pk_bf16_f32 v74, v68, v69
  v_cvt_pk_bf16_f32 v75, v70, v71
  v_exp_f32 v66, v58
  v_exp_f32 v67, v59
  v_mfma_f32_32x32x16_bf16 v[208:223], v[104:107], v[72:75], v[208:223]
  v_exp_f32 v68, v60
  v_exp_f32 v69, v61
  v_cvt_pk_bf16_f32 v76, v64, v65
  v_cvt_pk_bf16_f32 v77, v66, v67
  v_exp_f32 v70, v62
  v_exp_f32 v71, v63
  v_mfma_f32_32x32x16_bf16 v[48:63], v[240:243], v[136:139], 0
  v_exp_f32 v64, v32
  v_exp_f32 v65, v33
  v_cvt_pk_bf16_f32 v78, v68, v69
  v_cvt_pk_bf16_f32 v79, v70, v71
  v_exp_f32 v66, v34
  v_exp_f32 v67, v35
  v_mfma_f32_32x32x16_bf16 v[208:223], v[108:111], v[76:79], v[208:223]
  v_exp_f32 v68, v36
  v_exp_f32 v69, v37
  v_cvt_pk_bf16_f32 v72, v64, v65
  v_cvt_pk_bf16_f32 v73, v66, v67
  v_exp_f32 v70, v38
  v_exp_f32 v71, v39
  v_mfma_f32_32x32x16_bf16 v[48:63], v[244:247], v[140:143], v[48:63]
  buffer_load_dwordx4 v[96:99], v1, s[16:19], s75 offen offset:0 sc1
  v_exp_f32 v64, v40
  v_exp_f32 v65, v41
  v_cvt_pk_bf16_f32 v74, v68, v69
  v_cvt_pk_bf16_f32 v75, v70, v71
  v_exp_f32 v66, v42
  v_exp_f32 v67, v43
  v_mfma_f32_32x32x16_bf16 v[160:175], v[248:251], v[72:75], v[160:175]
  v_exp_f32 v68, v44
  v_exp_f32 v69, v45
  v_cvt_pk_bf16_f32 v76, v64, v65
  v_cvt_pk_bf16_f32 v77, v66, v67
  v_exp_f32 v70, v46
  v_exp_f32 v71, v47
  v_mfma_f32_32x32x16_bf16 v[32:47], v[240:243], v[144:147], 0
  v_exp_f32 v64, v48
  v_exp_f32 v65, v49
  v_cvt_pk_bf16_f32 v78, v68, v69
  v_cvt_pk_bf16_f32 v79, v70, v71
  v_exp_f32 v66, v50
  v_exp_f32 v67, v51
  v_mfma_f32_32x32x16_bf16 v[160:175], v[252:255], v[76:79], v[160:175]
  v_exp_f32 v68, v52
  v_exp_f32 v69, v53
  v_cvt_pk_bf16_f32 v72, v64, v65
  v_cvt_pk_bf16_f32 v73, v66, v67
  v_exp_f32 v70, v54
  v_exp_f32 v71, v55
  v_mfma_f32_32x32x16_bf16 v[32:47], v[244:247], v[148:151], v[32:47]
  buffer_load_dwordx4 v[100:103], v1, s[16:19], s75 offen offset:1024 sc1
  v_exp_f32 v64, v56
  v_exp_f32 v65, v57
  v_cvt_pk_bf16_f32 v74, v68, v69
  v_cvt_pk_bf16_f32 v75, v70, v71
  v_exp_f32 v66, v58
  v_exp_f32 v67, v59
  v_mfma_f32_32x32x16_bf16 v[176:191], v[248:251], v[72:75], v[176:191]
  v_exp_f32 v68, v60
  v_exp_f32 v69, v61
  v_cvt_pk_bf16_f32 v76, v64, v65
  v_cvt_pk_bf16_f32 v77, v66, v67
  v_exp_f32 v70, v62
  v_exp_f32 v71, v63
  v_mfma_f32_32x32x16_bf16 v[48:63], v[240:243], v[152:155], 0
  v_exp_f32 v64, v32
  v_exp_f32 v65, v33
  v_cvt_pk_bf16_f32 v78, v68, v69
  v_cvt_pk_bf16_f32 v79, v70, v71
  v_exp_f32 v66, v34
  v_exp_f32 v67, v35
  v_mfma_f32_32x32x16_bf16 v[176:191], v[252:255], v[76:79], v[176:191]
  v_exp_f32 v68, v36
  v_exp_f32 v69, v37
  v_cvt_pk_bf16_f32 v72, v64, v65
  v_cvt_pk_bf16_f32 v73, v66, v67
  v_exp_f32 v70, v38
  v_exp_f32 v71, v39
  v_mfma_f32_32x32x16_bf16 v[48:63], v[244:247], v[156:159], v[48:63]
  buffer_load_dwordx4 v[104:107], v1, s[16:19], s75 offen offset:2048 sc1
  v_exp_f32 v64, v40
  v_exp_f32 v65, v41
  v_cvt_pk_bf16_f32 v74, v68, v69
  v_cvt_pk_bf16_f32 v75, v70, v71
  v_exp_f32 v66, v42
  v_exp_f32 v67, v43
  v_mfma_f32_32x32x16_bf16 v[192:207], v[248:251], v[72:75], v[192:207]
  v_exp_f32 v68, v44
  v_exp_f32 v69, v45
  v_cvt_pk_bf16_f32 v76, v64, v65
  v_cvt_pk_bf16_f32 v77, v66, v67
  v_exp_f32 v70, v46
  v_exp_f32 v71, v47
  s_waitcnt vmcnt(7)
  v_mfma_f32_32x32x16_bf16 v[32:47], v[224:227], v[128:131], 0
  v_exp_f32 v64, v48
  v_exp_f32 v65, v49
  v_cvt_pk_bf16_f32 v78, v68, v69
  v_cvt_pk_bf16_f32 v79, v70, v71
  v_exp_f32 v66, v50
  v_exp_f32 v67, v51
  v_mfma_f32_32x32x16_bf16 v[192:207], v[252:255], v[76:79], v[192:207]
  v_exp_f32 v68, v52
  v_exp_f32 v69, v53
  v_cvt_pk_bf16_f32 v72, v64, v65
  v_cvt_pk_bf16_f32 v73, v66, v67
  v_exp_f32 v70, v54
  v_exp_f32 v71, v55
  v_mfma_f32_32x32x16_bf16 v[32:47], v[228:231], v[132:135], v[32:47]
  buffer_load_dwordx4 v[108:111], v1, s[16:19], s75 offen offset:3072 sc1
  v_exp_f32 v64, v56
  v_exp_f32 v65, v57
  v_cvt_pk_bf16_f32 v74, v68, v69
  v_cvt_pk_bf16_f32 v75, v70, v71
  v_exp_f32 v66, v58
  v_exp_f32 v67, v59
  v_mfma_f32_32x32x16_bf16 v[208:223], v[248:251], v[72:75], v[208:223]
  v_exp_f32 v68, v60
  v_exp_f32 v69, v61
  v_cvt_pk_bf16_f32 v76, v64, v65
  v_cvt_pk_bf16_f32 v77, v66, v67
  v_exp_f32 v70, v62
  v_exp_f32 v71, v63
  v_mfma_f32_32x32x16_bf16 v[48:63], v[224:227], v[136:139], 0
  v_exp_f32 v64, v32
  v_exp_f32 v65, v33
  v_cvt_pk_bf16_f32 v78, v68, v69
  v_cvt_pk_bf16_f32 v79, v70, v71
  v_exp_f32 v66, v34
  v_exp_f32 v67, v35
  v_mfma_f32_32x32x16_bf16 v[208:223], v[252:255], v[76:79], v[208:223]
  v_exp_f32 v68, v36
  v_exp_f32 v69, v37
  v_cvt_pk_bf16_f32 v72, v64, v65
  v_cvt_pk_bf16_f32 v73, v66, v67
  v_exp_f32 v70, v38
  v_exp_f32 v71, v39
  v_mfma_f32_32x32x16_bf16 v[48:63], v[228:231], v[140:143], v[48:63]
  buffer_load_dwordx4 v[240:243], v1, s[16:19], s76 offen offset:0 sc1
  v_exp_f32 v64, v40
  v_exp_f32 v65, v41
  v_cvt_pk_bf16_f32 v74, v68, v69
  v_cvt_pk_bf16_f32 v75, v70, v71
  v_exp_f32 v66, v42
  v_exp_f32 v67, v43
  v_mfma_f32_32x32x16_bf16 v[160:175], v[232:235], v[72:75], v[160:175]
  v_exp_f32 v68, v44
  v_exp_f32 v69, v45
  v_cvt_pk_bf16_f32 v76, v64, v65
  v_cvt_pk_bf16_f32 v77, v66, v67
  v_exp_f32 v70, v46
  v_exp_f32 v71, v47
  v_mfma_f32_32x32x16_bf16 v[32:47], v[224:227], v[144:147], 0
  v_exp_f32 v64, v48
  v_exp_f32 v65, v49
  v_cvt_pk_bf16_f32 v78, v68, v69
  v_cvt_pk_bf16_f32 v79, v70, v71
  v_exp_f32 v66, v50
  v_exp_f32 v67, v51
  v_mfma_f32_32x32x16_bf16 v[160:175], v[236:239], v[76:79], v[160:175]
  v_exp_f32 v68, v52
  v_exp_f32 v69, v53
  v_cvt_pk_bf16_f32 v72, v64, v65
  v_cvt_pk_bf16_f32 v73, v66, v67
  v_exp_f32 v70, v54
  v_exp_f32 v71, v55
  v_mfma_f32_32x32x16_bf16 v[32:47], v[228:231], v[148:151], v[32:47]
  buffer_load_dwordx4 v[244:247], v1, s[16:19], s76 offen offset:1024 sc1
  v_exp_f32 v64, v56
  v_exp_f32 v65, v57
  v_cvt_pk_bf16_f32 v74, v68, v69
  v_cvt_pk_bf16_f32 v75, v70, v71
  v_exp_f32 v66, v58
  v_exp_f32 v67, v59
  v_mfma_f32_32x32x16_bf16 v[176:191], v[232:235], v[72:75], v[176:191]
  v_exp_f32 v68, v60
  v_exp_f32 v69, v61
  v_cvt_pk_bf16_f32 v76, v64, v65
  v_cvt_pk_bf16_f32 v77, v66, v67
  v_exp_f32 v70, v62
  v_exp_f32 v71, v63
  v_mfma_f32_32x32x16_bf16 v[48:63], v[224:227], v[152:155], 0
  v_exp_f32 v64, v32
  v_exp_f32 v65, v33
  v_cvt_pk_bf16_f32 v78, v68, v69
  v_cvt_pk_bf16_f32 v79, v70, v71
  v_exp_f32 v66, v34
  v_exp_f32 v67, v35
  v_mfma_f32_32x32x16_bf16 v[176:191], v[236:239], v[76:79], v[176:191]
  v_exp_f32 v68, v36
  v_exp_f32 v69, v37
  v_cvt_pk_bf16_f32 v72, v64, v65
  v_cvt_pk_bf16_f32 v73, v66, v67
  v_exp_f32 v70, v38
  v_exp_f32 v71, v39
  v_mfma_f32_32x32x16_bf16 v[48:63], v[228:231], v[156:159], v[48:63]
  buffer_load_dwordx4 v[248:251], v1, s[16:19], s76 offen offset:2048 sc1
  v_exp_f32 v64, v40
  v_exp_f32 v65, v41
  v_cvt_pk_bf16_f32 v74, v68, v69
  v_cvt_pk_bf16_f32 v75, v70, v71
  v_exp_f32 v66, v42
  v_exp_f32 v67, v43
  v_mfma_f32_32x32x16_bf16 v[192:207], v[232:235], v[72:75], v[192:207]
  v_exp_f32 v68, v44
  v_exp_f32 v69, v45
  v_cvt_pk_bf16_f32 v76, v64, v65
  v_cvt_pk_bf16_f32 v77, v66, v67
  v_exp_f32 v70, v46
  v_exp_f32 v71, v47
  s_waitcnt vmcnt(7)
  v_mfma_f32_32x32x16_bf16 v[32:47], v[80:83], v[128:131], 0
  v_exp_f32 v64, v48
  v_exp_f32 v65, v49
  v_cvt_pk_bf16_f32 v78, v68, v69
  v_cvt_pk_bf16_f32 v79, v70, v71
  v_exp_f32 v66, v50
  v_exp_f32 v67, v51
  v_mfma_f32_32x32x16_bf16 v[192:207], v[236:239], v[76:79], v[192:207]
  v_exp_f32 v68, v52
  v_exp_f32 v69, v53
  v_cvt_pk_bf16_f32 v72, v64, v65
  v_cvt_pk_bf16_f32 v73, v66, v67
  v_exp_f32 v70, v54
  v_exp_f32 v71, v55
  v_mfma_f32_32x32x16_bf16 v[32:47], v[84:87], v[132:135], v[32:47]
  buffer_load_dwordx4 v[252:255], v1, s[16:19], s76 offen offset:3072 sc1
  v_exp_f32 v64, v56
  v_exp_f32 v65, v57
  v_cvt_pk_bf16_f32 v74, v68, v69
  v_cvt_pk_bf16_f32 v75, v70, v71
  v_exp_f32 v66, v58
  v_exp_f32 v67, v59
  v_mfma_f32_32x32x16_bf16 v[208:223], v[232:235], v[72:75], v[208:223]
  v_exp_f32 v68, v60
  v_exp_f32 v69, v61
  v_cvt_pk_bf16_f32 v76, v64, v65
  v_cvt_pk_bf16_f32 v77, v66, v67
  v_exp_f32 v70, v62
  v_exp_f32 v71, v63
  v_mfma_f32_32x32x16_bf16 v[48:63], v[80:83], v[136:139], 0
  v_exp_f32 v64, v32
  v_exp_f32 v65, v33
  v_cvt_pk_bf16_f32 v78, v68, v69
  v_cvt_pk_bf16_f32 v79, v70, v71
  v_exp_f32 v66, v34
  v_exp_f32 v67, v35
  v_mfma_f32_32x32x16_bf16 v[208:223], v[236:239], v[76:79], v[208:223]
  v_exp_f32 v68, v36
  v_exp_f32 v69, v37
  v_cvt_pk_bf16_f32 v72, v64, v65
  v_cvt_pk_bf16_f32 v73, v66, v67
  v_exp_f32 v70, v38
  v_exp_f32 v71, v39
  v_mfma_f32_32x32x16_bf16 v[48:63], v[84:87], v[140:143], v[48:63]
  buffer_load_dwordx4 v[224:227], v1, s[16:19], s77 offen offset:0 sc1
  v_exp_f32 v64, v40
  v_exp_f32 v65, v41
  v_cvt_pk_bf16_f32 v74, v68, v69
  v_cvt_pk_bf16_f32 v75, v70, v71
  v_exp_f32 v66, v42
  v_exp_f32 v67, v43
  v_mfma_f32_32x32x16_bf16 v[160:175], v[88:91], v[72:75], v[160:175]
  v_exp_f32 v68, v44
  v_exp_f32 v69, v45
  v_cvt_pk_bf16_f32 v76, v64, v65
  v_cvt_pk_bf16_f32 v77, v66, v67
  v_exp_f32 v70, v46
  v_exp_f32 v71, v47
  v_mfma_f32_32x32x16_bf16 v[32:47], v[80:83], v[144:147], 0
  v_exp_f32 v64, v48
  v_exp_f32 v65, v49
  v_cvt_pk_bf16_f32 v78, v68, v69
  v_cvt_pk_bf16_f32 v79, v70, v71
  v_exp_f32 v66, v50
  v_exp_f32 v67, v51
  v_mfma_f32_32x32x16_bf16 v[160:175], v[92:95], v[76:79], v[160:175]
  v_exp_f32 v68, v52
  v_exp_f32 v69, v53
  v_cvt_pk_bf16_f32 v72, v64, v65
  v_cvt_pk_bf16_f32 v73, v66, v67
  v_exp_f32 v70, v54
  v_exp_f32 v71, v55
  v_mfma_f32_32x32x16_bf16 v[32:47], v[84:87], v[148:151], v[32:47]
  buffer_load_dwordx4 v[228:231], v1, s[16:19], s77 offen offset:1024 sc1
  v_exp_f32 v64, v56
  v_exp_f32 v65, v57
  v_cvt_pk_bf16_f32 v74, v68, v69
  v_cvt_pk_bf16_f32 v75, v70, v71
  v_exp_f32 v66, v58
  v_exp_f32 v67, v59
  v_mfma_f32_32x32x16_bf16 v[176:191], v[88:91], v[72:75], v[176:191]
  v_exp_f32 v68, v60
  v_exp_f32 v69, v61
  v_cvt_pk_bf16_f32 v76, v64, v65
  v_cvt_pk_bf16_f32 v77, v66, v67
  v_exp_f32 v70, v62
  v_exp_f32 v71, v63
  v_mfma_f32_32x32x16_bf16 v[48:63], v[80:83], v[152:155], 0
  v_exp_f32 v64, v32
  v_exp_f32 v65, v33
  v_cvt_pk_bf16_f32 v78, v68, v69
  v_cvt_pk_bf16_f32 v79, v70, v71
  v_exp_f32 v66, v34
  v_exp_f32 v67, v35
  v_mfma_f32_32x32x16_bf16 v[176:191], v[92:95], v[76:79], v[176:191]
  v_exp_f32 v68, v36
  v_exp_f32 v69, v37
  v_cvt_pk_bf16_f32 v72, v64, v65
  v_cvt_pk_bf16_f32 v73, v66, v67
  v_exp_f32 v70, v38
  v_exp_f32 v71, v39
  v_mfma_f32_32x32x16_bf16 v[48:63], v[84:87], v[156:159], v[48:63]
  buffer_load_dwordx4 v[232:235], v1, s[16:19], s77 offen offset:2048 sc1
  v_exp_f32 v64, v40
  v_exp_f32 v65, v41
  v_cvt_pk_bf16_f32 v74, v68, v69
  v_cvt_pk_bf16_f32 v75, v70, v71
  v_exp_f32 v66, v42
  v_exp_f32 v67, v43
  v_mfma_f32_32x32x16_bf16 v[192:207], v[88:91], v[72:75], v[192:207]
  v_exp_f32 v68, v44
  v_exp_f32 v69, v45
  v_cvt_pk_bf16_f32 v76, v64, v65
  v_cvt_pk_bf16_f32 v77, v66, v67
  v_exp_f32 v70, v46
  v_exp_f32 v71, v47
  s_waitcnt vmcnt(7)
  v_mfma_f32_32x32x16_bf16 v[32:47], v[96:99], v[128:131], 0
  v_exp_f32 v64, v48
  v_exp_f32 v65, v49
  v_cvt_pk_bf16_f32 v78, v68, v69
  v_cvt_pk_bf16_f32 v79, v70, v71
  v_exp_f32 v66, v50
  v_exp_f32 v67, v51
  v_mfma_f32_32x32x16_bf16 v[192:207], v[92:95], v[76:79], v[192:207]
  v_exp_f32 v68, v52
  v_exp_f32 v69, v53
  v_cvt_pk_bf16_f32 v72, v64, v65
  v_cvt_pk_bf16_f32 v73, v66, v67
  v_exp_f32 v70, v54
  v_exp_f32 v71, v55
  v_mfma_f32_32x32x16_bf16 v[32:47], v[100:103], v[132:135], v[32:47]
  buffer_load_dwordx4 v[236:239], v1, s[16:19], s77 offen offset:3072 sc1
  v_exp_f32 v64, v56
  v_exp_f32 v65, v57
  v_cvt_pk_bf16_f32 v74, v68, v69
  v_cvt_pk_bf16_f32 v75, v70, v71
  v_exp_f32 v66, v58
  v_exp_f32 v67, v59
  v_mfma_f32_32x32x16_bf16 v[208:223], v[88:91], v[72:75], v[208:223]
  v_exp_f32 v68, v60
  v_exp_f32 v69, v61
  v_cvt_pk_bf16_f32 v76, v64, v65
  v_cvt_pk_bf16_f32 v77, v66, v67
  v_exp_f32 v70, v62
  v_exp_f32 v71, v63
  v_mfma_f32_32x32x16_bf16 v[48:63], v[96:99], v[136:139], 0
  v_exp_f32 v64, v32
  v_exp_f32 v65, v33
  v_cvt_pk_bf16_f32 v78, v68, v69
  v_cvt_pk_bf16_f32 v79, v70, v71
  v_exp_f32 v66, v34
  v_exp_f32 v67, v35
  v_mfma_f32_32x32x16_bf16 v[208:223], v[92:95], v[76:79], v[208:223]
  v_exp_f32 v68, v36
  v_exp_f32 v69, v37
  v_cvt_pk_bf16_f32 v72, v64, v65
  v_cvt_pk_bf16_f32 v73, v66, v67
  v_exp_f32 v70, v38
  v_exp_f32 v71, v39
  v_mfma_f32_32x32x16_bf16 v[48:63], v[100:103], v[140:143], v[48:63]
  buffer_load_dwordx4 v[80:83], v1, s[16:19], s78 offen offset:0 sc1
  v_exp_f32 v64, v40
  v_exp_f32 v65, v41
  v_cvt_pk_bf16_f32 v74, v68, v69
  v_cvt_pk_bf16_f32 v75, v70, v71
  v_exp_f32 v66, v42
  v_exp_f32 v67, v43
  v_mfma_f32_32x32x16_bf16 v[160:175], v[104:107], v[72:75], v[160:175]
  v_exp_f32 v68, v44
  v_exp_f32 v69, v45
  v_cvt_pk_bf16_f32 v76, v64, v65
  v_cvt_pk_bf16_f32 v77, v66, v67
  v_exp_f32 v70, v46
  v_exp_f32 v71, v47
  v_mfma_f32_32x32x16_bf16 v[32:47], v[96:99], v[144:147], 0
  v_exp_f32 v64, v48
  v_exp_f32 v65, v49
  v_cvt_pk_bf16_f32 v78, v68, v69
  v_cvt_pk_bf16_f32 v79, v70, v71
  v_exp_f32 v66, v50
  v_exp_f32 v67, v51
  v_mfma_f32_32x32x16_bf16 v[160:175], v[108:111], v[76:79], v[160:175]
  v_exp_f32 v68, v52
  v_exp_f32 v69, v53
  v_cvt_pk_bf16_f32 v72, v64, v65
  v_cvt_pk_bf16_f32 v73, v66, v67
  v_exp_f32 v70, v54
  v_exp_f32 v71, v55
  v_mfma_f32_32x32x16_bf16 v[32:47], v[100:103], v[148:151], v[32:47]
  buffer_load_dwordx4 v[84:87], v1, s[16:19], s78 offen offset:1024 sc1
  v_exp_f32 v64, v56
  v_exp_f32 v65, v57
  v_cvt_pk_bf16_f32 v74, v68, v69
  v_cvt_pk_bf16_f32 v75, v70, v71
  v_exp_f32 v66, v58
  v_exp_f32 v67, v59
  v_mfma_f32_32x32x16_bf16 v[176:191], v[104:107], v[72:75], v[176:191]
  v_exp_f32 v68, v60
  v_exp_f32 v69, v61
  v_cvt_pk_bf16_f32 v76, v64, v65
  v_cvt_pk_bf16_f32 v77, v66, v67
  v_exp_f32 v70, v62
  v_exp_f32 v71, v63
  v_mfma_f32_32x32x16_bf16 v[48:63], v[96:99], v[152:155], 0
  v_exp_f32 v64, v32
  v_exp_f32 v65, v33
  v_cvt_pk_bf16_f32 v78, v68, v69
  v_cvt_pk_bf16_f32 v79, v70, v71
  v_exp_f32 v66, v34
  v_exp_f32 v67, v35
  v_mfma_f32_32x32x16_bf16 v[176:191], v[108:111], v[76:79], v[176:191]
  v_exp_f32 v68, v36
  v_exp_f32 v69, v37
  v_cvt_pk_bf16_f32 v72, v64, v65
  v_cvt_pk_bf16_f32 v73, v66, v67
  v_exp_f32 v70, v38
  v_exp_f32 v71, v39
  v_mfma_f32_32x32x16_bf16 v[48:63], v[100:103], v[156:159], v[48:63]
  buffer_load_dwordx4 v[88:91], v1, s[16:19], s78 offen offset:2048 sc1
  v_exp_f32 v64, v40
  v_exp_f32 v65, v41
  v_cvt_pk_bf16_f32 v74, v68, v69
  v_cvt_pk_bf16_f32 v75, v70, v71
  v_exp_f32 v66, v42
  v_exp_f32 v67, v43
  v_mfma_f32_32x32x16_bf16 v[192:207], v[104:107], v[72:75], v[192:207]
  v_exp_f32 v68, v44
  v_exp_f32 v69, v45
  v_cvt_pk_bf16_f32 v76, v64, v65
  v_cvt_pk_bf16_f32 v77, v66, v67
  v_exp_f32 v70, v46
  v_exp_f32 v71, v47
  s_waitcnt vmcnt(7)
  v_mfma_f32_32x32x16_bf16 v[32:47], v[240:243], v[128:131], 0
  v_exp_f32 v64, v48
  v_exp_f32 v65, v49
  v_cvt_pk_bf16_f32 v78, v68, v69
  v_cvt_pk_bf16_f32 v79, v70, v71
  v_exp_f32 v66, v50
  v_exp_f32 v67, v51
  v_mfma_f32_32x32x16_bf16 v[192:207], v[108:111], v[76:79], v[192:207]
  v_exp_f32 v68, v52
  v_exp_f32 v69, v53
  v_cvt_pk_bf16_f32 v72, v64, v65
  v_cvt_pk_bf16_f32 v73, v66, v67
  v_exp_f32 v70, v54
  v_exp_f32 v71, v55
  v_mfma_f32_32x32x16_bf16 v[32:47], v[244:247], v[132:135], v[32:47]
  buffer_load_dwordx4 v[92:95], v1, s[16:19], s78 offen offset:3072 sc1
  v_exp_f32 v64, v56
  v_exp_f32 v65, v57
  v_cvt_pk_bf16_f32 v74, v68, v69
  v_cvt_pk_bf16_f32 v75, v70, v71
  v_exp_f32 v66, v58
  v_exp_f32 v67, v59
  v_mfma_f32_32x32x16_bf16 v[208:223], v[104:107], v[72:75], v[208:223]
  v_exp_f32 v68, v60
  v_exp_f32 v69, v61
  v_cvt_pk_bf16_f32 v76, v64, v65
  v_cvt_pk_bf16_f32 v77, v66, v67
  v_exp_f32 v70, v62
  v_exp_f32 v71, v63
  v_mfma_f32_32x32x16_bf16 v[48:63], v[240:243], v[136:139], 0
  v_exp_f32 v64, v32
  v_exp_f32 v65, v33
  v_cvt_pk_bf16_f32 v78, v68, v69
  v_cvt_pk_bf16_f32 v79, v70, v71
  v_exp_f32 v66, v34
  v_exp_f32 v67, v35
  v_mfma_f32_32x32x16_bf16 v[208:223], v[108:111], v[76:79], v[208:223]
  v_exp_f32 v68, v36
  v_exp_f32 v69, v37
  v_cvt_pk_bf16_f32 v72, v64, v65
  v_cvt_pk_bf16_f32 v73, v66, v67
  v_exp_f32 v70, v38
  v_exp_f32 v71, v39
  v_mfma_f32_32x32x16_bf16 v[48:63], v[244:247], v[140:143], v[48:63]
  buffer_load_dwordx4 v[96:99], v1, s[16:19], s79 offen offset:0 sc1
  v_exp_f32 v64, v40
  v_exp_f32 v65, v41
  v_cvt_pk_bf16_f32 v74, v68, v69
  v_cvt_pk_bf16_f32 v75, v70, v71
  v_exp_f32 v66, v42
  v_exp_f32 v67, v43
  v_mfma_f32_32x32x16_bf16 v[160:175], v[248:251], v[72:75], v[160:175]
  v_exp_f32 v68, v44
  v_exp_f32 v69, v45
  v_cvt_pk_bf16_f32 v76, v64, v65
  v_cvt_pk_bf16_f32 v77, v66, v67
  v_exp_f32 v70, v46
  v_exp_f32 v71, v47
  v_mfma_f32_32x32x16_bf16 v[32:47], v[240:243], v[144:147], 0
  v_and_b32 v22, 31, v0
  v_lshrrev_b32 v23, 5, v0
  v_lshlrev_b32 v23, 3, v23
  v_mul_u32_u24 v22, 896, v22
  v_exp_f32 v64, v48
  v_exp_f32 v65, v49
  v_cvt_pk_bf16_f32 v78, v68, v69
  v_cvt_pk_bf16_f32 v79, v70, v71
  v_exp_f32 v66, v50
  v_exp_f32 v67, v51
  v_mfma_f32_32x32x16_bf16 v[160:175], v[252:255], v[76:79], v[160:175]
  v_exp_f32 v68, v52
  v_exp_f32 v69, v53
  v_cvt_pk_bf16_f32 v72, v64, v65
  v_cvt_pk_bf16_f32 v73, v66, v67
  v_exp_f32 v70, v54
  v_exp_f32 v71, v55
  v_mfma_f32_32x32x16_bf16 v[32:47], v[244:247], v[148:151], v[32:47]
  buffer_load_dwordx4 v[100:103], v1, s[16:19], s79 offen offset:1024 sc1
  v_exp_f32 v64, v56
  v_exp_f32 v65, v57
  v_cvt_pk_bf16_f32 v74, v68, v69
  v_cvt_pk_bf16_f32 v75, v70, v71
  v_exp_f32 v66, v58
  v_exp_f32 v67, v59
  v_mfma_f32_32x32x16_bf16 v[176:191], v[248:251], v[72:75], v[176:191]
  v_exp_f32 v68, v60
  v_exp_f32 v69, v61
  v_cvt_pk_bf16_f32 v76, v64, v65
  v_cvt_pk_bf16_f32 v77, v66, v67
  v_exp_f32 v70, v62
  v_exp_f32 v71, v63
  v_mfma_f32_32x32x16_bf16 v[48:63], v[240:243], v[152:155], 0
  v_add_u32 v22, v22, v23
  v_exp_f32 v64, v32
  v_exp_f32 v65, v33
  v_cvt_pk_bf16_f32 v78, v68, v69
  v_cvt_pk_bf16_f32 v79, v70, v71
  v_exp_f32 v66, v34
  v_exp_f32 v67, v35
  v_mfma_f32_32x32x16_bf16 v[176:191], v[252:255], v[76:79], v[176:191]
  v_exp_f32 v68, v36
  v_exp_f32 v69, v37
  v_cvt_pk_bf16_f32 v72, v64, v65
  v_cvt_pk_bf16_f32 v73, v66, v67
  v_exp_f32 v70, v38
  v_exp_f32 v71, v39
  v_mfma_f32_32x32x16_bf16 v[48:63], v[244:247], v[156:159], v[48:63]
  buffer_load_dwordx4 v[104:107], v1, s[16:19], s79 offen offset:2048 sc1
  v_exp_f32 v64, v40
  v_exp_f32 v65, v41
  v_cvt_pk_bf16_f32 v74, v68, v69
  v_cvt_pk_bf16_f32 v75, v70, v71
  v_exp_f32 v66, v42
  v_exp_f32 v67, v43
  v_mfma_f32_32x32x16_bf16 v[192:207], v[248:251], v[72:75], v[192:207]
  v_exp_f32 v68, v44
  v_exp_f32 v69, v45
  v_cvt_pk_bf16_f32 v76, v64, v65
  v_cvt_pk_bf16_f32 v77, v66, v67
  v_exp_f32 v70, v46
  v_exp_f32 v71, v47
  s_waitcnt vmcnt(7)
  v_mfma_f32_32x32x16_bf16 v[32:47], v[224:227], v[128:131], 0
  v_exp_f32 v64, v48
  v_exp_f32 v65, v49
  v_cvt_pk_bf16_f32 v78, v68, v69
  v_cvt_pk_bf16_f32 v79, v70, v71
  v_exp_f32 v66, v50
  v_exp_f32 v67, v51
  v_mfma_f32_32x32x16_bf16 v[192:207], v[252:255], v[76:79], v[192:207]
  v_exp_f32 v68, v52
  v_exp_f32 v69, v53
  v_cvt_pk_bf16_f32 v72, v64, v65
  v_cvt_pk_bf16_f32 v73, v66, v67
  v_exp_f32 v70, v54
  v_exp_f32 v71, v55
  v_mfma_f32_32x32x16_bf16 v[32:47], v[228:231], v[132:135], v[32:47]
  buffer_load_dwordx4 v[108:111], v1, s[16:19], s79 offen offset:3072 sc1
  v_exp_f32 v64, v56
  v_exp_f32 v65, v57
  v_cvt_pk_bf16_f32 v74, v68, v69
  v_cvt_pk_bf16_f32 v75, v70, v71
  v_exp_f32 v66, v58
  v_exp_f32 v67, v59
  v_mfma_f32_32x32x16_bf16 v[208:223], v[248:251], v[72:75], v[208:223]
  v_exp_f32 v68, v60
  v_exp_f32 v69, v61
  v_cvt_pk_bf16_f32 v76, v64, v65
  v_cvt_pk_bf16_f32 v77, v66, v67
  v_exp_f32 v70, v62
  v_exp_f32 v71, v63
  v_mfma_f32_32x32x16_bf16 v[48:63], v[224:227], v[136:139], 0
  buffer_load_dwordx2 v[120:121], v23, s[40:43], s35 offen offset:0
  v_exp_f32 v64, v32
  v_exp_f32 v65, v33
  v_cvt_pk_bf16_f32 v78, v68, v69
  v_cvt_pk_bf16_f32 v79, v70, v71
  v_exp_f32 v66, v34
  v_exp_f32 v67, v35
  v_mfma_f32_32x32x16_bf16 v[208:223], v[252:255], v[76:79], v[208:223]
  v_exp_f32 v68, v36
  v_exp_f32 v69, v37
  v_cvt_pk_bf16_f32 v72, v64, v65
  v_cvt_pk_bf16_f32 v73, v66, v67
  v_exp_f32 v70, v38
  v_exp_f32 v71, v39
  v_mfma_f32_32x32x16_bf16 v[48:63], v[228:231], v[140:143], v[48:63]
  v_exp_f32 v64, v40
  v_exp_f32 v65, v41
  v_cvt_pk_bf16_f32 v74, v68, v69
  v_cvt_pk_bf16_f32 v75, v70, v71
  v_exp_f32 v66, v42
  v_exp_f32 v67, v43
  v_mfma_f32_32x32x16_bf16 v[160:175], v[232:235], v[72:75], v[160:175]
  v_exp_f32 v68, v44
  v_exp_f32 v69, v45
  v_cvt_pk_bf16_f32 v76, v64, v65
  v_cvt_pk_bf16_f32 v77, v66, v67
  v_exp_f32 v70, v46
  v_exp_f32 v71, v47
  v_mfma_f32_32x32x16_bf16 v[32:47], v[224:227], v[144:147], 0
  buffer_load_dwordx2 v[122:123], v23, s[40:43], s35 offen offset:16
  buffer_load_dwordx2 v[240:241], v22, s[8:11], s34 offen offset:0
  v_exp_f32 v64, v48
  v_exp_f32 v65, v49
  v_cvt_pk_bf16_f32 v78, v68, v69
  v_cvt_pk_bf16_f32 v79, v70, v71
  v_exp_f32 v66, v50
  v_exp_f32 v67, v51
  v_mfma_f32_32x32x16_bf16 v[160:175], v[236:239], v[76:79], v[160:175]
  v_exp_f32 v68, v52
  v_exp_f32 v69, v53
  v_cvt_pk_bf16_f32 v72, v64, v65
  v_cvt_pk_bf16_f32 v73, v66, v67
  v_exp_f32 v70, v54
  v_exp_f32 v71, v55
  v_mfma_f32_32x32x16_bf16 v[32:47], v[228:231], v[148:151], v[32:47]
  v_exp_f32 v64, v56
  v_exp_f32 v65, v57
  v_cvt_pk_bf16_f32 v74, v68, v69
  v_cvt_pk_bf16_f32 v75, v70, v71
  v_exp_f32 v66, v58
  v_exp_f32 v67, v59
  v_mfma_f32_32x32x16_bf16 v[176:191], v[232:235], v[72:75], v[176:191]
  v_exp_f32 v68, v60
  v_exp_f32 v69, v61
  v_cvt_pk_bf16_f32 v76, v64, v65
  v_cvt_pk_bf16_f32 v77, v66, v67
  v_exp_f32 v70, v62
  v_exp_f32 v71, v63
  v_mfma_f32_32x32x16_bf16 v[48:63], v[224:227], v[152:155], 0
  buffer_load_dwordx2 v[124:125], v23, s[40:43], s35 offen offset:32
  buffer_load_dwordx2 v[242:243], v22, s[8:11], s34 offen offset:16
  v_exp_f32 v64, v32
  v_exp_f32 v65, v33
  v_cvt_pk_bf16_f32 v78, v68, v69
  v_cvt_pk_bf16_f32 v79, v70, v71
  v_exp_f32 v66, v34
  v_exp_f32 v67, v35
  v_mfma_f32_32x32x16_bf16 v[176:191], v[236:239], v[76:79], v[176:191]
  v_exp_f32 v68, v36
  v_exp_f32 v69, v37
  v_cvt_pk_bf16_f32 v72, v64, v65
  v_cvt_pk_bf16_f32 v73, v66, v67
  v_exp_f32 v70, v38
  v_exp_f32 v71, v39
  v_mfma_f32_32x32x16_bf16 v[48:63], v[228:231], v[156:159], v[48:63]
  v_exp_f32 v64, v40
  v_exp_f32 v65, v41
  v_cvt_pk_bf16_f32 v74, v68, v69
  v_cvt_pk_bf16_f32 v75, v70, v71
  v_exp_f32 v66, v42
  v_exp_f32 v67, v43
  v_mfma_f32_32x32x16_bf16 v[192:207], v[232:235], v[72:75], v[192:207]
  v_exp_f32 v68, v44
  v_exp_f32 v69, v45
  v_cvt_pk_bf16_f32 v76, v64, v65
  v_cvt_pk_bf16_f32 v77, v66, v67
  v_exp_f32 v70, v46
  v_exp_f32 v71, v47
  s_waitcnt vmcnt(9)
  v_mfma_f32_32x32x16_bf16 v[32:47], v[80:83], v[128:131], 0
  buffer_load_dwordx2 v[126:127], v23, s[40:43], s35 offen offset:48
  buffer_load_dwordx2 v[244:245], v22, s[8:11], s34 offen offset:32
  v_exp_f32 v64, v48
  v_exp_f32 v65, v49
  v_cvt_pk_bf16_f32 v78, v68, v69
  v_cvt_pk_bf16_f32 v79, v70, v71
  v_exp_f32 v66, v50
  v_exp_f32 v67, v51
  v_mfma_f32_32x32x16_bf16 v[192:207], v[236:239], v[76:79], v[192:207]
  v_exp_f32 v68, v52
  v_exp_f32 v69, v53
  v_cvt_pk_bf16_f32 v72, v64, v65
  v_cvt_pk_bf16_f32 v73, v66, v67
  v_exp_f32 v70, v54
  v_exp_f32 v71, v55
  v_mfma_f32_32x32x16_bf16 v[32:47], v[84:87], v[132:135], v[32:47]
  v_exp_f32 v64, v56
  v_exp_f32 v65, v57
  v_cvt_pk_bf16_f32 v74, v68, v69
  v_cvt_pk_bf16_f32 v75, v70, v71
  v_exp_f32 v66, v58
  v_exp_f32 v67, v59
  v_mfma_f32_32x32x16_bf16 v[208:223], v[232:235], v[72:75], v[208:223]
  v_exp_f32 v68, v60
  v_exp_f32 v69, v61
  v_cvt_pk_bf16_f32 v76, v64, v65
  v_cvt_pk_bf16_f32 v77, v66, v67
  v_exp_f32 v70, v62
  v_exp_f32 v71, v63
  v_mfma_f32_32x32x16_bf16 v[48:63], v[80:83], v[136:139], 0
  buffer_load_dwordx2 v[246:247], v22, s[8:11], s34 offen offset:48
  v_lshlrev_b32 v5, 2, v0
  v_exp_f32 v64, v32
  v_exp_f32 v65, v33
  v_cvt_pk_bf16_f32 v78, v68, v69
  v_cvt_pk_bf16_f32 v79, v70, v71
  v_exp_f32 v66, v34
  v_exp_f32 v67, v35
  v_mfma_f32_32x32x16_bf16 v[208:223], v[236:239], v[76:79], v[208:223]
  v_exp_f32 v68, v36
  v_exp_f32 v69, v37
  v_cvt_pk_bf16_f32 v72, v64, v65
  v_cvt_pk_bf16_f32 v73, v66, v67
  v_exp_f32 v70, v38
  v_exp_f32 v71, v39
  v_mfma_f32_32x32x16_bf16 v[48:63], v[84:87], v[140:143], v[48:63]
  v_exp_f32 v64, v40
  v_exp_f32 v65, v41
  v_cvt_pk_bf16_f32 v74, v68, v69
  v_cvt_pk_bf16_f32 v75, v70, v71
  v_exp_f32 v66, v42
  v_exp_f32 v67, v43
  v_mfma_f32_32x32x16_bf16 v[160:175], v[88:91], v[72:75], v[160:175]
  v_exp_f32 v68, v44
  v_exp_f32 v69, v45
  v_cvt_pk_bf16_f32 v76, v64, v65
  v_cvt_pk_bf16_f32 v77, v66, v67
  v_exp_f32 v70, v46
  v_exp_f32 v71, v47
  v_mfma_f32_32x32x16_bf16 v[32:47], v[80:83], v[144:147], 0
  buffer_load_dword v4, v5, s[16:19], s94 offen sc1
  v_exp_f32 v64, v48
  v_exp_f32 v65, v49
  v_cvt_pk_bf16_f32 v78, v68, v69
  v_cvt_pk_bf16_f32 v79, v70, v71
  v_exp_f32 v66, v50
  v_exp_f32 v67, v51
  v_mfma_f32_32x32x16_bf16 v[160:175], v[92:95], v[76:79], v[160:175]
  v_exp_f32 v68, v52
  v_exp_f32 v69, v53
  v_cvt_pk_bf16_f32 v72, v64, v65
  v_cvt_pk_bf16_f32 v73, v66, v67
  v_exp_f32 v70, v54
  v_exp_f32 v71, v55
  v_mfma_f32_32x32x16_bf16 v[32:47], v[84:87], v[148:151], v[32:47]
  v_exp_f32 v64, v56
  v_exp_f32 v65, v57
  v_cvt_pk_bf16_f32 v74, v68, v69
  v_cvt_pk_bf16_f32 v75, v70, v71
  v_exp_f32 v66, v58
  v_exp_f32 v67, v59
  v_mfma_f32_32x32x16_bf16 v[176:191], v[88:91], v[72:75], v[176:191]
  v_exp_f32 v68, v60
  v_exp_f32 v69, v61
  v_cvt_pk_bf16_f32 v76, v64, v65
  v_cvt_pk_bf16_f32 v77, v66, v67
  v_exp_f32 v70, v62
  v_exp_f32 v71, v63
  v_mfma_f32_32x32x16_bf16 v[48:63], v[80:83], v[152:155], 0
  v_add_u32 v10, s36, v1
  v_add_u32 v11, s37, v1
  v_add_u32 v12, s38, v1
  v_add_u32 v13, s39, v1
  v_exp_f32 v64, v32
  v_exp_f32 v65, v33
  v_cvt_pk_bf16_f32 v78, v68, v69
  v_cvt_pk_bf16_f32 v79, v70, v71
  v_exp_f32 v66, v34
  v_exp_f32 v67, v35
  v_mfma_f32_32x32x16_bf16 v[176:191], v[92:95], v[76:79], v[176:191]
  v_exp_f32 v68, v36
  v_exp_f32 v69, v37
  v_cvt_pk_bf16_f32 v72, v64, v65
  v_cvt_pk_bf16_f32 v73, v66, v67
  v_exp_f32 v70, v38
  v_exp_f32 v71, v39
  v_mfma_f32_32x32x16_bf16 v[48:63], v[84:87], v[156:159], v[48:63]
  v_exp_f32 v64, v40
  v_exp_f32 v65, v41
  v_cvt_pk_bf16_f32 v74, v68, v69
  v_cvt_pk_bf16_f32 v75, v70, v71
  v_exp_f32 v66, v42
  v_exp_f32 v67, v43
  v_mfma_f32_32x32x16_bf16 v[192:207], v[88:91], v[72:75], v[192:207]
  v_exp_f32 v68, v44
  v_exp_f32 v69, v45
  v_cvt_pk_bf16_f32 v76, v64, v65
  v_cvt_pk_bf16_f32 v77, v66, v67
  v_exp_f32 v70, v46
  v_exp_f32 v71, v47
  s_waitcnt vmcnt(9)
  v_mfma_f32_32x32x16_bf16 v[32:47], v[96:99], v[128:131], 0
  v_mov_b32 v8, 0x5f800000
  v_exp_f32 v64, v48
  v_exp_f32 v65, v49
  v_cvt_pk_bf16_f32 v78, v68, v69
  v_cvt_pk_bf16_f32 v79, v70, v71
  v_exp_f32 v66, v50
  v_exp_f32 v67, v51
  v_mfma_f32_32x32x16_bf16 v[192:207], v[92:95], v[76:79], v[192:207]
  v_exp_f32 v68, v52
  v_exp_f32 v69, v53
  v_cvt_pk_bf16_f32 v72, v64, v65
  v_cvt_pk_bf16_f32 v73, v66, v67
  v_exp_f32 v70, v54
  v_exp_f32 v71, v55
  v_mfma_f32_32x32x16_bf16 v[32:47], v[100:103], v[132:135], v[32:47]
  v_exp_f32 v64, v56
  v_exp_f32 v65, v57
  v_cvt_pk_bf16_f32 v74, v68, v69
  v_cvt_pk_bf16_f32 v75, v70, v71
  v_exp_f32 v66, v58
  v_exp_f32 v67, v59
  v_mfma_f32_32x32x16_bf16 v[208:223], v[88:91], v[72:75], v[208:223]
  v_exp_f32 v68, v60
  v_exp_f32 v69, v61
  v_cvt_pk_bf16_f32 v76, v64, v65
  v_cvt_pk_bf16_f32 v77, v66, v67
  v_exp_f32 v70, v62
  v_exp_f32 v71, v63
  v_mfma_f32_32x32x16_bf16 v[48:63], v[96:99], v[136:139], 0
  v_exp_f32 v64, v32
  v_exp_f32 v65, v33
  v_cvt_pk_bf16_f32 v78, v68, v69
  v_cvt_pk_bf16_f32 v79, v70, v71
  v_exp_f32 v66, v34
  v_exp_f32 v67, v35
  v_mfma_f32_32x32x16_bf16 v[208:223], v[92:95], v[76:79], v[208:223]
  v_exp_f32 v68, v36
  v_exp_f32 v69, v37
  v_cvt_pk_bf16_f32 v72, v64, v65
  v_cvt_pk_bf16_f32 v73, v66, v67
  v_exp_f32 v70, v38
  v_exp_f32 v71, v39
  v_mfma_f32_32x32x16_bf16 v[48:63], v[100:103], v[140:143], v[48:63]
  v_exp_f32 v64, v40
  v_exp_f32 v65, v41
  v_cvt_pk_bf16_f32 v74, v68, v69
  v_cvt_pk_bf16_f32 v75, v70, v71
  v_exp_f32 v66, v42
  v_exp_f32 v67, v43
  v_mfma_f32_32x32x16_bf16 v[160:175], v[104:107], v[72:75], v[160:175]
  v_exp_f32 v68, v44
  v_exp_f32 v69, v45
  v_cvt_pk_bf16_f32 v76, v64, v65
  v_cvt_pk_bf16_f32 v77, v66, v67
  v_exp_f32 v70, v46
  v_exp_f32 v71, v47
  v_mfma_f32_32x32x16_bf16 v[32:47], v[96:99], v[144:147], 0
  v_exp_f32 v64, v48
  v_exp_f32 v65, v49
  v_cvt_pk_bf16_f32 v78, v68, v69
  v_cvt_pk_bf16_f32 v79, v70, v71
  v_exp_f32 v66, v50
  v_exp_f32 v67, v51
  v_mfma_f32_32x32x16_bf16 v[160:175], v[108:111], v[76:79], v[160:175]
  v_exp_f32 v68, v52
  v_exp_f32 v69, v53
  v_cvt_pk_bf16_f32 v72, v64, v65
  v_cvt_pk_bf16_f32 v73, v66, v67
  v_exp_f32 v70, v54
  v_exp_f32 v71, v55
  v_mfma_f32_32x32x16_bf16 v[32:47], v[100:103], v[148:151], v[32:47]
  v_exp_f32 v64, v56
  v_exp_f32 v65, v57
  v_cvt_pk_bf16_f32 v74, v68, v69
  v_cvt_pk_bf16_f32 v75, v70, v71
  v_exp_f32 v66, v58
  v_exp_f32 v67, v59
  v_mfma_f32_32x32x16_bf16 v[176:191], v[104:107], v[72:75], v[176:191]
  ds_write_b128 v10, v[160:163] offset:0
  v_exp_f32 v68, v60
  v_exp_f32 v69, v61
  v_cvt_pk_bf16_f32 v76, v64, v65
  v_cvt_pk_bf16_f32 v77, v66, v67
  v_exp_f32 v70, v62
  v_exp_f32 v71, v63
  v_mfma_f32_32x32x16_bf16 v[48:63], v[96:99], v[152:155], 0
  ds_write_b128 v10, v[164:167] offset:1024
  v_exp_f32 v64, v32
  v_exp_f32 v65, v33
  v_cvt_pk_bf16_f32 v78, v68, v69
  v_cvt_pk_bf16_f32 v79, v70, v71
  v_exp_f32 v66, v34
  v_exp_f32 v67, v35
  v_mfma_f32_32x32x16_bf16 v[176:191], v[108:111], v[76:79], v[176:191]
  ds_write_b128 v10, v[168:171] offset:2048
  v_exp_f32 v68, v36
  v_exp_f32 v69, v37
  v_cvt_pk_bf16_f32 v72, v64, v65
  v_cvt_pk_bf16_f32 v73, v66, v67
  v_exp_f32 v70, v38
  v_exp_f32 v71, v39
  v_mfma_f32_32x32x16_bf16 v[48:63], v[100:103], v[156:159], v[48:63]
  ds_write_b128 v10, v[172:175] offset:3072
  v_exp_f32 v64, v40
  v_exp_f32 v65, v41
  v_cvt_pk_bf16_f32 v74, v68, v69
  v_cvt_pk_bf16_f32 v75, v70, v71
  v_exp_f32 v66, v42
  v_exp_f32 v67, v43
  v_mfma_f32_32x32x16_bf16 v[192:207], v[104:107], v[72:75], v[192:207]
  ds_write_b128 v11, v[176:179] offset:0
  v_exp_f32 v68, v44
  v_exp_f32 v69, v45
  v_cvt_pk_bf16_f32 v76, v64, v65
  v_cvt_pk_bf16_f32 v77, v66, v67
  v_exp_f32 v70, v46
  v_exp_f32 v71, v47
  ds_write_b128 v11, v[180:183] offset:1024
  v_exp_f32 v64, v48
  v_exp_f32 v65, v49
  v_cvt_pk_bf16_f32 v78, v68, v69
  v_cvt_pk_bf16_f32 v79, v70, v71
  v_exp_f32 v66, v50
  v_exp_f32 v67, v51
  v_mfma_f32_32x32x16_bf16 v[192:207], v[108:111], v[76:79], v[192:207]
  ds_write_b128 v11, v[184:187] offset:2048
  v_exp_f32 v68, v52
  v_exp_f32 v69, v53
  v_cvt_pk_bf16_f32 v72, v64, v65
  v_cvt_pk_bf16_f32 v73, v66, v67
  v_exp_f32 v70, v54
  v_exp_f32 v71, v55
  ds_write_b128 v11, v[188:191] offset:3072
  v_exp_f32 v64, v56
  v_exp_f32 v65, v57
  v_cvt_pk_bf16_f32 v74, v68, v69
  v_cvt_pk_bf16_f32 v75, v70, v71
  v_exp_f32 v66, v58
  v_exp_f32 v67, v59
  v_mfma_f32_32x32x16_bf16 v[208:223], v[104:107], v[72:75], v[208:223]
  ds_write_b128 v12, v[192:195] offset:0
  v_exp_f32 v68, v60
  v_exp_f32 v69, v61
  v_cvt_pk_bf16_f32 v76, v64, v65
  v_cvt_pk_bf16_f32 v77, v66, v67
  v_exp_f32 v70, v62
  v_exp_f32 v71, v63
  v_cvt_pk_bf16_f32 v78, v68, v69
  v_cvt_pk_bf16_f32 v79, v70, v71
  v_add_f32 v9, v172, v188
  v_add_f32 v9, v9, v204
  v_mfma_f32_32x32x16_bf16 v[208:223], v[108:111], v[76:79], v[208:223]
  ds_write_b128 v12, v[196:199] offset:1024
  ds_write_b128 v12, v[200:203] offset:2048
  ds_write_b128 v12, v[204:207] offset:3072
L_clpoll:
  s_waitcnt vmcnt(0)
  v_cmp_ne_u32 vcc, s49, v4
  s_cbranch_vccz L_clok
  s_add_u32 s96, s96, 1
  s_cmp_gt_u32 s96, 131072
  s_cbranch_scc1 L_clok
  buffer_load_dword v4, v5, s[16:19], s94 offen sc1
  s_branch L_clpoll
L_clok:
  s_nop 5
  v_add_f32 v9, v9, v220
  v_cmp_nlt_f32 vcc, v9, v8
  s_andn2_b64 vcc, vcc, s[86:87]
  s_cbranch_vccnz L_bad
L_badok:
  s_waitcnt lgkmcnt(0)
  s_barrier
  s_and_b32 s61, s2, 0xe7
  s_lshl_b32 s61, s61, 2
  s_add_u32 s61, s61, 14336
  v_and_b32 v26, 3, v0
  v_lshlrev_b32 v26, 5, v26
  buffer_load_dword v28, v26, s[16:19], s61 offen sc1
  ds_read_b128 v[172:175], v13 offset:3072
  ds_read_b128 v[188:191], v13 offset:7168
  ds_read_b128 v[204:207], v13 offset:11264
  ds_read_b128 v[160:163], v13 offset:0
  ds_read_b128 v[176:179], v13 offset:4096
  ds_read_b128 v[192:195], v13 offset:8192
  ds_read_b128 v[164:167], v13 offset:1024
  ds_read_b128 v[180:183], v13 offset:5120
  ds_read_b128 v[196:199], v13 offset:9216
  ds_read_b128 v[168:171], v13 offset:2048
  ds_read_b128 v[184:187], v13 offset:6144
  ds_read_b128 v[200:203], v13 offset:10240
  s_waitcnt lgkmcnt(9)
  v_pk_add_f32 v[220:221], v[220:221], v[172:173]
  v_pk_add_f32 v[188:189], v[188:189], v[204:205]
  v_pk_add_f32 v[222:223], v[222:223], v[174:175]
  v_pk_add_f32 v[190:191], v[190:191], v[206:207]
  v_pk_add_f32 v[220:221], v[220:221], v[188:189]
  v_pk_add_f32 v[222:223], v[222:223], v[190:191]
  v_mov_b32 v8, v220
  v_mov_b32 v9, v220
  v_readlane_b32 s61, v221, 32
  s_nop 0
  v_permlane32_swap_b32 v8, v9
  s_cmp_eq_u32 s61, 0
  s_cbranch_scc1 L_noredo
  s_cmp_eq_u32 s97, 0
  s_cbranch_scc1 L_redo
L_noredo:
  v_rcp_f32 v8, v9
  s_waitcnt lgkmcnt(6)
  v_pk_add_f32 v[208:209], v[208:209], v[160:161]
  v_pk_add_f32 v[176:177], v[176:177], v[192:193]
  v_pk_add_f32 v[210:211], v[210:211], v[162:163]
  v_pk_add_f32 v[178:179], v[178:179], v[194:195]
  v_pk_add_f32 v[208:209], v[208:209], v[176:177]
  v_pk_add_f32 v[210:211], v[210:211], v[178:179]
  s_waitcnt lgkmcnt(3)
  v_pk_add_f32 v[212:213], v[212:213], v[164:165]
  v_pk_add_f32 v[180:181], v[180:181], v[196:197]
  v_pk_add_f32 v[214:215], v[214:215], v[166:167]
  v_pk_add_f32 v[182:183], v[182:183], v[198:199]
  v_pk_add_f32 v[212:213], v[212:213], v[180:181]
  v_pk_add_f32 v[214:215], v[214:215], v[182:183]
  s_waitcnt lgkmcnt(0)
  v_pk_add_f32 v[216:217], v[216:217], v[168:169]
  v_pk_add_f32 v[184:185], v[184:185], v[200:201]
  v_pk_add_f32 v[218:219], v[218:219], v[170:171]
  v_pk_add_f32 v[186:187], v[186:187], v[202:203]
  v_pk_add_f32 v[216:217], v[216:217], v[184:185]
  v_pk_add_f32 v[218:219], v[218:219], v[186:187]
  v_pk_mul_f32 v[208:209], v[208:209], v[8:9] op_sel_hi:[1,0]
  v_pk_mul_f32 v[210:211], v[210:211], v[8:9] op_sel_hi:[1,0]
  v_pk_mul_f32 v[212:213], v[212:213], v[8:9] op_sel_hi:[1,0]
  v_pk_mul_f32 v[214:215], v[214:215], v[8:9] op_sel_hi:[1,0]
  v_cvt_pk_bf16_f32 v32, v208, v209
  v_cvt_pk_bf16_f32 v33, v210, v211
  v_cvt_pk_bf16_f32 v34, v212, v213
  v_cvt_pk_bf16_f32 v35, v214, v215
  buffer_store_dwordx4 v[32:35], v1, s[16:19], s99 offen offset:0 sc1
  v_pk_mul_f32 v[216:217], v[216:217], v[8:9] op_sel_hi:[1,0]
  v_pk_mul_f32 v[218:219], v[218:219], v[8:9] op_sel_hi:[1,0]
  v_pk_mul_f32 v[220:221], v[220:221], v[8:9] op_sel_hi:[1,0]
  v_pk_mul_f32 v[222:223], v[222:223], v[8:9] op_sel_hi:[1,0]
  v_cvt_pk_bf16_f32 v36, v216, v217
  v_cvt_pk_bf16_f32 v37, v218, v219
  v_cvt_pk_bf16_f32 v38, v220, v221
  v_cvt_pk_bf16_f32 v39, v222, v223
  v_cndmask_b32 v38, 0, v38, s[86:87]
  v_cndmask_b32 v39, 0, v39, s[86:87]
  buffer_store_dwordx4 v[36:39], v1, s[16:19], s99 offen offset:1024 sc1
  s_or_b32 s61, s2, s44
  s_cmp_lg_u32 s61, 0
  s_cbranch_scc1 L_noepoch
  s_mov_b64 exec, 1
  buffer_store_dword v30, v31, s[16:19], 0 offen sc1
  s_mov_b64 exec, -1
L_noepoch:
  v_lshrrev_b32 v23, 5, v0
  v_lshrrev_b32 v25, 2, v0
  v_and_b32 v25, 3, v25
  v_add_u32 v24, s44, v25
  v_and_b32 v24, 3, v24
  v_lshl_add_u32 v25, v23, 2, v25
  v_lshlrev_b32 v25, 8, v25
  v_lshl_add_u32 v25, v24, 6, v25
  v_lshrrev_b32 v26, 4, v0
  v_and_b32 v26, 1, v26
  v_lshl_add_u32 v25, v26, 5, v25
  v_lshrrev_b32 v27, 1, v0
  v_and_b32 v27, v27, v26
  v_and_b32 v26, 3, v0
  v_xor_b32 v26, v26, v27
  v_lshl_add_u32 v25, v26, 3, v25
  v_lshlrev_b32 v23, 11, v23
  s_add_u32 s61, s44, 0
  s_and_b32 s61, s61, 3
  s_lshl_b32 s62, s61, 13
  s_add_u32 s62, s62, 114688
  s_mul_i32 s61, s61, 28672
  v_add_u32 v2, s62, v1
  v_add_u32 v6, s61, v25
  v_sub_u32 v10, v6, v23
  s_add_u32 s61, s44, 1
  s_and_b32 s61, s61, 3
  s_lshl_b32 s62, s61, 13
  s_add_u32 s62, s62, 114688
  s_mul_i32 s61, s61, 28672
  v_add_u32 v3, s62, v1
  v_add_u32 v7, s61, v25
  v_sub_u32 v11, v7, v23
  s_add_u32 s61, s44, 2
  s_and_b32 s61, s61, 3
  s_lshl_b32 s62, s61, 13
  s_add_u32 s62, s62, 114688
  s_mul_i32 s61, s61, 28672
  v_add_u32 v4, s62, v1
  v_add_u32 v8, s61, v25
  v_sub_u32 v12, v8, v23
  s_add_u32 s61, s44, 3
  s_and_b32 s61, s61, 3
  s_lshl_b32 s62, s61, 13
  s_add_u32 s62, s62, 114688
  s_mul_i32 s61, s61, 28672
  v_add_u32 v5, s62, v1
  v_add_u32 v9, s61, v25
  v_sub_u32 v13, v9, v23
  v_lshlrev_b32 v64, 16, v240
  v_and_b32 v65, 0xffff0000, v240
  v_lshlrev_b32 v66, 16, v241
  v_and_b32 v67, 0xffff0000, v241
  v_lshlrev_b32 v68, 16, v242
  v_and_b32 v69, 0xffff0000, v242
  v_lshlrev_b32 v70, 16, v243
  v_and_b32 v71, 0xffff0000, v243
  v_lshlrev_b32 v72, 16, v244
  v_and_b32 v73, 0xffff0000, v244
  v_lshlrev_b32 v74, 16, v245
  v_and_b32 v75, 0xffff0000, v245
  v_lshlrev_b32 v76, 16, v246
  v_and_b32 v77, 0xffff0000, v246
  v_lshlrev_b32 v78, 16, v247
  v_and_b32 v79, 0xffff0000, v247
  v_cndmask_b32 v46, 0, v126, s[86:87]
  v_cndmask_b32 v47, 0, v127, s[86:87]
  v_mov_b32 v21, 0
  v_mov_b32 v40, v120
  v_mov_b32 v41, v121
  v_mov_b32 v42, v122
  v_mov_b32 v43, v123
  v_mov_b32 v44, v124
  v_mov_b32 v45, v125
  v_dot2c_f32_bf16 v21, s60, v40
  v_dot2c_f32_bf16 v21, s60, v41
  v_dot2c_f32_bf16 v21, s60, v42
  v_dot2c_f32_bf16 v21, s60, v43
  v_dot2c_f32_bf16 v21, s60, v44
  v_dot2c_f32_bf16 v21, s60, v45
  v_dot2c_f32_bf16 v21, s60, v46
  v_dot2c_f32_bf16 v21, s60, v47
  s_lshl_b32 s90, s47, 2
  s_add_u32 s90, s90, s44
  s_lshl_b32 s90, s90, 13
  s_add_u32 s90, s90, 5767168
  s_add_u32 s91, s90, 4096
  s_lshl_b32 s92, s44, 13
  s_add_u32 s92, s92, 114688
  s_add_u32 s93, s92, 4096
  s_waitcnt vmcnt(0)
  s_getreg_b32 s61, hwreg(HW_REG_XCC_ID)
  v_cmp_ne_u32 s[56:57], s61, v28
  s_barrier
  s_mov_b32 m0, s92
  s_nop 0
  buffer_load_dwordx4 v1, s[16:19], s90 offen offset:0 sc1 lds
  buffer_load_dwordx4 v1, s[16:19], s90 offen offset:1024 sc1 lds
  buffer_load_dwordx4 v1, s[16:19], s90 offen offset:2048 sc1 lds
  buffer_load_dwordx4 v1, s[16:19], s90 offen offset:3072 sc1 lds
  s_mov_b32 m0, s93
  s_nop 0
  buffer_load_dwordx4 v1, s[16:19], s91 offen offset:0 sc1 lds
  buffer_load_dwordx4 v1, s[16:19], s91 offen offset:1024 sc1 lds
  buffer_load_dwordx4 v1, s[16:19], s91 offen offset:2048 sc1 lds
  buffer_load_dwordx4 v1, s[16:19], s91 offen offset:3072 sc1 lds
  ds_read_b64_tr_b16 v[128:129], v6 offset:0
  ds_read_b64_tr_b16 v[130:131], v6 offset:2048
  ds_read_b64_tr_b16 v[132:133], v6 offset:4096
  ds_read_b64_tr_b16 v[134:135], v10 offset:6144
  ds_read_b64_tr_b16 v[136:137], v6 offset:7168
  ds_read_b64_tr_b16 v[138:139], v6 offset:9216
  ds_read_b64_tr_b16 v[140:141], v6 offset:11264
  ds_read_b64_tr_b16 v[142:143], v10 offset:13312
  ds_read_b64_tr_b16 v[144:145], v6 offset:14336
  ds_read_b64_tr_b16 v[146:147], v6 offset:16384
  ds_read_b64_tr_b16 v[148:149], v6 offset:18432
  ds_read_b64_tr_b16 v[150:151], v10 offset:20480
  ds_read_b64_tr_b16 v[152:153], v6 offset:21504
  ds_read_b64_tr_b16 v[154:155], v6 offset:23552
  ds_read_b64_tr_b16 v[156:157], v6 offset:25600
  ds_read_b64_tr_b16 v[158:159], v10 offset:27648
  ds_read_b64_tr_b16 v[160:161], v7 offset:0
  ds_read_b64_tr_b16 v[162:163], v7 offset:2048
  ds_read_b64_tr_b16 v[164:165], v7 offset:4096
  ds_read_b64_tr_b16 v[166:167], v11 offset:6144
  ds_read_b64_tr_b16 v[168:169], v7 offset:7168
  ds_read_b64_tr_b16 v[170:171], v7 offset:9216
  ds_read_b64_tr_b16 v[172:173], v7 offset:11264
  ds_read_b64_tr_b16 v[174:175], v11 offset:13312
  ds_read_b64_tr_b16 v[176:177], v7 offset:14336
  ds_read_b64_tr_b16 v[178:179], v7 offset:16384
  ds_read_b64_tr_b16 v[180:181], v7 offset:18432
  ds_read_b64_tr_b16 v[182:183], v11 offset:20480
  ds_read_b64_tr_b16 v[184:185], v7 offset:21504
  ds_read_b64_tr_b16 v[186:187], v7 offset:23552
  ds_read_b64_tr_b16 v[188:189], v7 offset:25600
  ds_read_b64_tr_b16 v[190:191], v11 offset:27648
  ds_read_b64_tr_b16 v[192:193], v8 offset:0
  ds_read_b64_tr_b16 v[194:195], v8 offset:2048
  ds_read_b64_tr_b16 v[196:197], v8 offset:4096
  ds_read_b64_tr_b16 v[198:199], v12 offset:6144
  ds_read_b64_tr_b16 v[200:201], v8 offset:7168
  ds_read_b64_tr_b16 v[202:203], v8 offset:9216
  ds_read_b64_tr_b16 v[204:205], v8 offset:11264
  ds_read_b64_tr_b16 v[206:207], v12 offset:13312
  ds_read_b64_tr_b16 v[208:209], v8 offset:14336
  ds_read_b64_tr_b16 v[210:211], v8 offset:16384
  ds_read_b64_tr_b16 v[212:213], v8 offset:18432
  ds_read_b64_tr_b16 v[214:215], v12 offset:20480
  ds_read_b64_tr_b16 v[216:217], v8 offset:21504
  ds_read_b64_tr_b16 v[218:219], v8 offset:23552
  ds_read_b64_tr_b16 v[220:221], v8 offset:25600
  ds_read_b64_tr_b16 v[222:223], v12 offset:27648
  ds_read_b64_tr_b16 v[224:225], v9 offset:0
  ds_read_b64_tr_b16 v[226:227], v9 offset:2048
  ds_read_b64_tr_b16 v[228:229], v9 offset:4096
  ds_read_b64_tr_b16 v[230:231], v13 offset:6144
  ds_read_b64_tr_b16 v[232:233], v9 offset:7168
  ds_read_b64_tr_b16 v[234:235], v9 offset:9216
  ds_read_b64_tr_b16 v[236:237], v9 offset:11264
  ds_read_b64_tr_b16 v[238:239], v13 offset:13312
  ds_read_b64_tr_b16 v[240:241], v9 offset:14336
  ds_read_b64_tr_b16 v[242:243], v9 offset:16384
  ds_read_b64_tr_b16 v[244:245], v9 offset:18432
  ds_read_b64_tr_b16 v[246:247], v13 offset:20480
  ds_read_b64_tr_b16 v[248:249], v9 offset:21504
  ds_read_b64_tr_b16 v[250:251], v9 offset:23552
  ds_read_b64_tr_b16 v[252:253], v9 offset:25600
  ds_read_b64_tr_b16 v[254:255], v13 offset:27648
  s_branch L_owait
L_odma:
  s_mov_b32 m0, s92
  s_nop 0
  buffer_load_dwordx4 v1, s[16:19], s90 offen offset:0 sc1 lds
  buffer_load_dwordx4 v1, s[16:19], s90 offen offset:1024 sc1 lds
  buffer_load_dwordx4 v1, s[16:19], s90 offen offset:2048 sc1 lds
  buffer_load_dwordx4 v1, s[16:19], s90 offen offset:3072 sc1 lds
  s_mov_b32 m0, s93
  s_nop 0
  buffer_load_dwordx4 v1, s[16:19], s91 offen offset:0 sc1 lds
  buffer_load_dwordx4 v1, s[16:19], s91 offen offset:1024 sc1 lds
  buffer_load_dwordx4 v1, s[16:19], s91 offen offset:2048 sc1 lds
  buffer_load_dwordx4 v1, s[16:19], s91 offen offset:3072 sc1 lds
L_owait:
  s_waitcnt vmcnt(0)
  ds_read_b128 v[80:83], v2 offset:0
  ds_read_b128 v[84:87], v2 offset:1024
  ds_read_b128 v[88:91], v2 offset:2048
  ds_read_b128 v[92:95], v2 offset:3072
  ds_read_b128 v[96:99], v2 offset:4096
  ds_read_b128 v[100:103], v2 offset:5120
  ds_read_b128 v[104:107], v2 offset:6144
  ds_read_b128 v[108:111], v2 offset:7168
  s_waitcnt lgkmcnt(7)
  v_mfma_f32_32x32x16_bf16 v[48:63], v[128:131], v[80:83], v[64:79]
  s_waitcnt lgkmcnt(4)
  v_max3_u32 v22, v80, v81, v80
  v_max3_u32 v23, v82, v83, v82
  v_max3_u32 v22, v84, v85, v22
  v_max3_u32 v23, v86, v87, v23
  v_max3_u32 v22, v88, v89, v22
  v_max3_u32 v23, v90, v91, v23
  v_max3_u32 v22, v92, v93, v22
  v_max3_u32 v23, v94, v95, v23
  s_waitcnt lgkmcnt(6)
  v_mfma_f32_32x32x16_bf16 v[48:63], v[132:135], v[84:87], v[48:63]
  s_waitcnt lgkmcnt(0)
  v_max3_u32 v22, v96, v97, v22
  v_max3_u32 v23, v98, v99, v23
  v_max3_u32 v22, v100, v101, v22
  v_max3_u32 v23, v102, v103, v23
  v_max3_u32 v22, v104, v105, v22
  v_max3_u32 v23, v106, v107, v23
  v_max3_u32 v22, v108, v109, v22
  v_max3_u32 v23, v110, v111, v23
  v_max_u32 v22, v22, v23
  v_cmp_eq_u32 vcc, -1, v22
  s_cbranch_vccz L_ook
  s_add_u32 s96, s96, 1
  s_cmp_gt_u32 s96, 131072
  s_cbranch_scc1 L_ook
  s_branch L_odma
L_ook:
  s_barrier
  s_waitcnt lgkmcnt(5)
  v_mfma_f32_32x32x16_bf16 v[48:63], v[136:139], v[88:91], v[48:63]
  ds_read_b128 v[112:115], v3 offset:0
  ds_read_b128 v[116:119], v3 offset:1024
  s_waitcnt lgkmcnt(6)
  v_mfma_f32_32x32x16_bf16 v[48:63], v[140:143], v[92:95], v[48:63]
  ds_read_b128 v[120:123], v3 offset:2048
  ds_read_b128 v[124:127], v3 offset:3072
  s_waitcnt lgkmcnt(7)
  v_mfma_f32_32x32x16_bf16 v[48:63], v[144:147], v[96:99], v[48:63]
  ds_read_b128 v[80:83], v3 offset:4096
  s_waitcnt lgkmcnt(7)
  v_mfma_f32_32x32x16_bf16 v[48:63], v[148:151], v[100:103], v[48:63]
  ds_read_b128 v[84:87], v3 offset:5120
  s_waitcnt lgkmcnt(7)
  v_mfma_f32_32x32x16_bf16 v[48:63], v[152:155], v[104:107], v[48:63]
  ds_read_b128 v[88:91], v3 offset:6144
  s_waitcnt lgkmcnt(7)
  v_mfma_f32_32x32x16_bf16 v[48:63], v[156:159], v[108:111], v[48:63]
  ds_read_b128 v[92:95], v3 offset:7168
  s_waitcnt lgkmcnt(7)
  v_mfma_f32_32x32x16_bf16 v[48:63], v[160:163], v[112:115], v[48:63]
  ds_read_b128 v[96:99], v4 offset:0
  s_waitcnt lgkmcnt(7)
  v_mfma_f32_32x32x16_bf16 v[48:63], v[164:167], v[116:119], v[48:63]
  ds_read_b128 v[100:103], v4 offset:1024
  s_waitcnt lgkmcnt(7)
  v_mfma_f32_32x32x16_bf16 v[48:63], v[168:171], v[120:123], v[48:63]
  ds_read_b128 v[104:107], v4 offset:2048
  s_waitcnt lgkmcnt(7)
  v_mfma_f32_32x32x16_bf16 v[48:63], v[172:175], v[124:127], v[48:63]
  ds_read_b128 v[108:111], v4 offset:3072
  s_waitcnt lgkmcnt(7)
  v_mfma_f32_32x32x16_bf16 v[48:63], v[176:179], v[80:83], v[48:63]
  ds_read_b128 v[112:115], v4 offset:4096
  s_waitcnt lgkmcnt(7)
  v_mfma_f32_32x32x16_bf16 v[48:63], v[180:183], v[84:87], v[48:63]
  ds_read_b128 v[116:119], v4 offset:5120
  s_waitcnt lgkmcnt(7)
  v_mfma_f32_32x32x16_bf16 v[48:63], v[184:187], v[88:91], v[48:63]
  ds_read_b128 v[120:123], v4 offset:6144
  s_waitcnt lgkmcnt(7)
  v_mfma_f32_32x32x16_bf16 v[48:63], v[188:191], v[92:95], v[48:63]
  ds_read_b128 v[124:127], v4 offset:7168
  s_waitcnt lgkmcnt(7)
  v_mfma_f32_32x32x16_bf16 v[48:63], v[192:195], v[96:99], v[48:63]
  ds_read_b128 v[80:83], v5 offset:0
  s_waitcnt lgkmcnt(7)
  v_mfma_f32_32x32x16_bf16 v[48:63], v[196:199], v[100:103], v[48:63]
  ds_read_b128 v[84:87], v5 offset:1024
  s_waitcnt lgkmcnt(7)
  v_mfma_f32_32x32x16_bf16 v[48:63], v[200:203], v[104:107], v[48:63]
  ds_read_b128 v[88:91], v5 offset:2048
  s_waitcnt lgkmcnt(7)
  v_mfma_f32_32x32x16_bf16 v[48:63], v[204:207], v[108:111], v[48:63]
  ds_read_b128 v[92:95], v5 offset:3072
  s_waitcnt lgkmcnt(7)
  v_mfma_f32_32x32x16_bf16 v[48:63], v[208:211], v[112:115], v[48:63]
  ds_read_b128 v[96:99], v5 offset:4096
  s_waitcnt lgkmcnt(7)
  v_mfma_f32_32x32x16_bf16 v[48:63], v[212:215], v[116:119], v[48:63]
  ds_read_b128 v[100:103], v5 offset:5120
  s_waitcnt lgkmcnt(7)
  v_mfma_f32_32x32x16_bf16 v[48:63], v[216:219], v[120:123], v[48:63]
  ds_read_b128 v[104:107], v5 offset:6144
  s_waitcnt lgkmcnt(7)
  v_mfma_f32_32x32x16_bf16 v[48:63], v[220:223], v[124:127], v[48:63]
  ds_read_b128 v[108:111], v5 offset:7168
  s_waitcnt lgkmcnt(7)
  v_mfma_f32_32x32x16_bf16 v[48:63], v[224:227], v[80:83], v[48:63]
  s_waitcnt lgkmcnt(6)
  v_mfma_f32_32x32x16_bf16 v[48:63], v[228:231], v[84:87], v[48:63]
  s_waitcnt lgkmcnt(5)
  v_mfma_f32_32x32x16_bf16 v[48:63], v[232:235], v[88:91], v[48:63]
  s_waitcnt lgkmcnt(4)
  v_mfma_f32_32x32x16_bf16 v[48:63], v[236:239], v[92:95], v[48:63]
  s_waitcnt lgkmcnt(3)
  v_mfma_f32_32x32x16_bf16 v[48:63], v[240:243], v[96:99], v[48:63]
  s_waitcnt lgkmcnt(2)
  v_mfma_f32_32x32x16_bf16 v[48:63], v[244:247], v[100:103], v[48:63]
  s_waitcnt lgkmcnt(1)
  v_mfma_f32_32x32x16_bf16 v[48:63], v[248:251], v[104:107], v[48:63]
  s_waitcnt lgkmcnt(0)
  v_mfma_f32_32x32x16_bf16 v[48:63], v[252:255], v[108:111], v[48:63]
  v_and_b32 v22, 31, v0
  v_lshrrev_b32 v23, 5, v0
  v_lshlrev_b32 v23, 3, v23
  v_lshl_add_u32 v17, v22, 4, v23
  s_lshl_b32 s61, s44, 9
  s_add_u32 s61, s61, 147456
  v_add_u32 v18, s61, v17
  v_add_u32 v19, 147456, v17
  v_mul_u32_u24 v22, 240, v22
  s_mul_i32 s61, s44, 56
  s_add_u32 s61, s61, 114688
  v_add3_u32 v14, v22, v23, s61
  v_mov_b32 v24, 0
  v_mov_b32 v25, 0
  v_mov_b32 v26, 0
  v_cvt_pk_bf16_f32 v32, v48, v49
  v_cvt_pk_bf16_f32 v33, v50, v51
  v_cvt_pk_bf16_f32 v34, v52, v53
  v_cvt_pk_bf16_f32 v35, v54, v55
  v_cvt_pk_bf16_f32 v36, v56, v57
  v_cvt_pk_bf16_f32 v37, v58, v59
  v_cvt_pk_bf16_f32 v38, v60, v61
  v_cvt_pk_bf16_f32 v39, v62, v63
  v_cndmask_b32 v38, 0, v38, s[86:87]
  v_cndmask_b32 v39, 0, v39, s[86:87]
  v_dot2c_f32_bf16 v24, s60, v32
  v_dot2c_f32_bf16 v26, v32, v32
  v_dot2c_f32_bf16 v25, v40, v32
  v_dot2c_f32_bf16 v24, s60, v33
  v_dot2c_f32_bf16 v26, v33, v33
  v_dot2c_f32_bf16 v25, v41, v33
  v_dot2c_f32_bf16 v24, s60, v34
  v_dot2c_f32_bf16 v26, v34, v34
  v_dot2c_f32_bf16 v25, v42, v34
  v_dot2c_f32_bf16 v24, s60, v35
  v_dot2c_f32_bf16 v26, v35, v35
  v_dot2c_f32_bf16 v25, v43, v35
  v_dot2c_f32_bf16 v24, s60, v36
  v_dot2c_f32_bf16 v26, v36, v36
  v_dot2c_f32_bf16 v25, v44, v36
  v_dot2c_f32_bf16 v24, s60, v37
  v_dot2c_f32_bf16 v26, v37, v37
  v_dot2c_f32_bf16 v25, v45, v37
  v_dot2c_f32_bf16 v24, s60, v38
  v_dot2c_f32_bf16 v26, v38, v38
  v_dot2c_f32_bf16 v25, v46, v38
  v_dot2c_f32_bf16 v24, s60, v39
  v_dot2c_f32_bf16 v26, v39, v39
  v_dot2c_f32_bf16 v25, v47, v39
  s_nop 1
  v_permlane32_swap_b32 v24, v26
  v_permlane32_swap_b32 v25, v21
  v_add_f32 v40, v24, v26
  v_add_f32 v41, v25, v21
  ds_write_b64 v18, v[40:41]
  s_lshl_b32 s90, s47, 11
  s_add_u32 s90, s90, 131072
  s_lshl_b32 s61, s48, 9
  s_add_u32 s91, s90, s61
  s_lshl_b32 s61, s44, 3
  s_lshl_b32 s61, 0xff, s61
  s_waitcnt lgkmcnt(0)
  s_barrier
  ds_read_b64 v[40:41], v19
  ds_read_b64 v[42:43], v19 offset:512
  ds_read_b64 v[44:45], v19 offset:1024
  ds_read_b64 v[46:47], v19 offset:1536
  s_waitcnt lgkmcnt(2)
  v_pk_add_f32 v[40:41], v[40:41], v[42:43]
  s_waitcnt lgkmcnt(0)
  v_pk_add_f32 v[44:45], v[44:45], v[46:47]
  v_pk_add_f32 v[40:41], v[40:41], v[44:45]
  v_mov_b32 v42, v40
  v_mov_b32 v43, v41
  s_nop 0
  v_permlane32_swap_b32 v40, v42
  v_permlane32_swap_b32 v41, v43
  s_mov_b32 exec_lo, s61
  s_mov_b32 exec_hi, 0
  s_cmp_eq_u64 s[56:57], 0
  s_cbranch_scc0 L_stfar
  buffer_store_dwordx4 v[40:43], v17, s[16:19], s91 offen
  s_branch L_stdone
L_stfar:
  buffer_store_dwordx4 v[40:43], v17, s[16:19], s91 offen sc1
L_stdone:
  s_mov_b64 exec, -1
  v_and_b32 v22, 31, v0
  v_lshrrev_b32 v23, 5, v0
  v_lshlrev_b32 v23, 10, v23
  v_lshl_add_u32 v17, v22, 4, v23
  v_add_u32 v23, 0, v0
  v_mul_u32_u24 v22, 4682, v23
  v_lshrrev_b32 v22, 16, v22
  v_mul_u32_u24 v27, 14, v22
  v_sub_u32 v23, v23, v27
  s_lshl_b32 s61, s44, 3
  v_add_u32 v22, s61, v22
  v_mov_b32 v20, v22
  v_mul_u32_u24 v27, 896, v22
  v_lshl_add_u32 v116, v23, 4, v27
  v_mul_u32_u24 v22, 240, v22
  v_lshl_add_u32 v22, v23, 4, v22
  v_add_u32 v15, 114688, v22
  v_add_u32 v23, 64, v0
  v_mul_u32_u24 v22, 4682, v23
  v_lshrrev_b32 v22, 16, v22
  v_mul_u32_u24 v27, 14, v22
  v_sub_u32 v23, v23, v27
  s_lshl_b32 s61, s44, 3
  v_add_u32 v22, s61, v22
  v_mov_b32 v21, v22
  v_mul_u32_u24 v27, 896, v22
  v_lshl_add_u32 v117, v23, 4, v27
  v_mul_u32_u24 v22, 240, v22
  v_lshl_add_u32 v22, v23, 4, v22
  v_add_u32 v16, 114688, v22
  v_mul_u32_u24 v22, 4682, v0
  v_lshrrev_b32 v22, 16, v22
  v_mul_u32_u24 v27, 14, v22
  v_sub_u32 v23, v0, v27
  v_mul_u32_u24 v27, 896, v22
  v_lshl_add_u32 v19, v23, 4, v27
  v_mul_u32_u24 v22, 240, v22
  v_lshl_add_u32 v22, v23, 4, v22
  s_mul_i32 s61, s44, 960
  s_add_u32 s61, s61, 122368
  v_add_u32 v18, s61, v22
  s_lshl_b32 s61, s47, 1
  s_and_b32 s62, s44, 1
  s_add_u32 s61, s61, s62
  s_mul_i32 s61, s61, 3584
  s_mul_i32 s62, s48, 224
  s_add_u32 s61, s61, s62
  s_lshr_b32 s62, s44, 1
  s_mul_i32 s62, s62, 524288
  s_add_u32 s61, s61, s62
  s_add_u32 s95, s61, 7864320
  v_lshlrev_b32 v64, 16, v32
  v_and_b32 v65, 0xffff0000, v32
  v_lshlrev_b32 v66, 16, v33
  v_and_b32 v67, 0xffff0000, v33
  v_lshlrev_b32 v68, 16, v34
  v_and_b32 v69, 0xffff0000, v34
  v_lshlrev_b32 v70, 16, v35
  v_and_b32 v71, 0xffff0000, v35
  v_lshlrev_b32 v72, 16, v36
  v_and_b32 v73, 0xffff0000, v36
  v_lshlrev_b32 v74, 16, v37
  v_and_b32 v75, 0xffff0000, v37
  v_lshlrev_b32 v76, 16, v38
  v_and_b32 v77, 0xffff0000, v38
  v_lshlrev_b32 v78, 16, v39
  v_and_b32 v79, 0xffff0000, v39
  v_and_b32 v27, 31, v0
  s_lshl_b32 s61, s47, 5
  s_sub_u32 s61, 2047, s61
  v_sub_u32 v27, s61, v27
  s_waitcnt vmcnt(0)
L_stpoll:
  buffer_load_dwordx4 v[40:43], v17, s[16:19], s90 offen offset:0 sc1
  buffer_load_dwordx4 v[44:47], v17, s[16:19], s90 offen offset:512 sc1
  s_waitcnt vmcnt(0)
  v_max3_u32 v22, v40, v41, v42
  v_max3_u32 v23, v43, v44, v45
  v_pk_add_f32 v[40:41], v[40:41], v[44:45]
  v_max3_u32 v22, v22, v46, v47
  v_pk_add_f32 v[42:43], v[42:43], v[46:47]
  v_max_u32 v22, v22, v23
  v_cmp_eq_u32 vcc, -1, v22
  s_cbranch_vccz L_stok
  s_add_u32 s96, s96, 1
  s_cmp_gt_u32 s96, 131072
  s_cbranch_scc1 L_stok
  s_branch L_stpoll
L_stok:
  v_permlane32_swap_b32 v40, v42
  v_permlane32_swap_b32 v41, v43
  v_pk_add_f32 v[40:41], v[40:41], v[42:43]
  v_mov_b32 v42, v40
  v_mov_b32 v43, v41
  s_nop 0
  v_permlane32_swap_b32 v40, v42
  v_permlane32_swap_b32 v41, v43
  v_mul_f32 v44, 0x3b124925, v40
  v_mul_f32 v22, 0x3b124925, v42
  v_fma_f32 v22, -v44, v44, v22
  v_max_f32 v22, 0, v22
  v_cvt_pk_bf16_f32 v23, v44, v22
  v_lshlrev_b32 v44, 16, v23
  v_and_b32 v22, 0xffff0000, v23
  v_add_f32 v22, 0x3727c5ac, v22
  v_cvt_pk_bf16_f32 v22, v22, v22
  v_and_b32 v22, 0xffff0000, v22
  v_sqrt_f32 v22, v22
  s_nop 0
  v_cvt_pk_bf16_f32 v22, v22, v22
  v_and_b32 v22, 0xffff0000, v22
  v_rcp_f32 v46, v22
  v_fma_f32 v41, -v44, v43, v41
  v_mul_f32 v41, v41, v46
  v_cvt_pk_bf16_f32 v41, v41, v41
  v_ashrrev_i32 v22, 31, v41
  v_or_b32 v22, 0x80000000, v22
  v_xor_b32 v41, v41, v22
  v_and_b32 v41, 0xffff0000, v41
  v_lshrrev_b32 v41, 1, v41
  v_or_b32 v47, v41, v27
  v_mov_b32 v48, v47
  v_mov_b32 v49, v47
  s_nop 1
  v_permlane16_swap_b32 v48, v49
  v_cndmask_b32 v48, v49, v48, s[86:87]
  v_sub_u32 v80, v48, v47
  s_nop 0
  v_sub_u32_dpp v81, v48, v47 row_ror:1 row_mask:0xf bank_mask:0xf bound_ctrl:1
  v_sub_u32_dpp v82, v48, v47 row_ror:2 row_mask:0xf bank_mask:0xf bound_ctrl:1
  v_sub_u32_dpp v83, v48, v47 row_ror:3 row_mask:0xf bank_mask:0xf bound_ctrl:1
  v_sub_u32_dpp v84, v48, v47 row_ror:4 row_mask:0xf bank_mask:0xf bound_ctrl:1
  v_sub_u32_dpp v85, v48, v47 row_ror:5 row_mask:0xf bank_mask:0xf bound_ctrl:1
  v_sub_u32_dpp v86, v48, v47 row_ror:6 row_mask:0xf bank_mask:0xf bound_ctrl:1
  v_sub_u32_dpp v87, v48, v47 row_ror:7 row_mask:0xf bank_mask:0xf bound_ctrl:1
  v_sub_u32_dpp v88, v48, v47 row_ror:8 row_mask:0xf bank_mask:0xf bound_ctrl:1
  v_sub_u32_dpp v89, v48, v47 row_ror:9 row_mask:0xf bank_mask:0xf bound_ctrl:1
  v_sub_u32_dpp v90, v48, v47 row_ror:10 row_mask:0xf bank_mask:0xf bound_ctrl:1
  v_sub_u32_dpp v91, v48, v47 row_ror:11 row_mask:0xf bank_mask:0xf bound_ctrl:1
  v_sub_u32_dpp v92, v48, v47 row_ror:12 row_mask:0xf bank_mask:0xf bound_ctrl:1
  v_sub_u32_dpp v93, v48, v47 row_ror:13 row_mask:0xf bank_mask:0xf bound_ctrl:1
  v_sub_u32_dpp v94, v48, v47 row_ror:14 row_mask:0xf bank_mask:0xf bound_ctrl:1
  v_sub_u32_dpp v95, v48, v47 row_ror:15 row_mask:0xf bank_mask:0xf bound_ctrl:1
  v_lshrrev_b32 v48, 31, v80
  v_lshrrev_b32 v49, 31, v81
  v_alignbit_b32 v48, v48, v82, 31
  v_alignbit_b32 v49, v49, v83, 31
  v_alignbit_b32 v48, v48, v84, 31
  v_alignbit_b32 v49, v49, v85, 31
  v_alignbit_b32 v48, v48, v86, 31
  v_alignbit_b32 v49, v49, v87, 31
  v_alignbit_b32 v48, v48, v88, 31
  v_alignbit_b32 v49, v49, v89, 31
  v_alignbit_b32 v48, v48, v90, 31
  v_alignbit_b32 v49, v49, v91, 31
  v_alignbit_b32 v48, v48, v92, 31
  v_alignbit_b32 v49, v49, v93, 31
  v_alignbit_b32 v48, v48, v94, 31
  v_alignbit_b32 v49, v49, v95, 31
  v_bcnt_u32_b32 v48, v48, 0
  v_bcnt_u32_b32 v48, v49, v48
  v_mov_b32 v49, v48
  s_nop 1
  v_permlane32_swap_b32 v48, v49
  v_add_u32 v48, v48, v49
  v_sub_u32 v48, 31, v48
  v_cmp_gt_u32 s[88:89], 8, v48
  v_lshlrev_b32 v49, 2, v48
  s_or_b32 s61, s44, s48
  s_cmp_lg_u32 s61, 0
  s_cbranch_scc1 L_norank
  ds_permute_b32 v49, v49, v47
  s_lshl_b32 s61, s47, 7
  s_add_u32 s61, s61, 16384
  v_lshlrev_b32 v22, 2, v0
  s_mov_b64 exec, 0xff
  s_waitcnt lgkmcnt(0)
  buffer_store_dword v49, v22, s[16:19], s61 offen sc1
  s_mov_b64 exec, -1
L_norank:
  v_and_b32 v22, 31, v0
  v_sub_u32 v22, v48, v22
  v_mul_i32_i24 v22, 240, v22
  v_add_u32 v13, v14, v22
  s_mov_b64 exec, s[88:89]
  ds_write_b64 v13, v[32:33] offset:9600
  ds_write_b64 v13, v[34:35] offset:9616
  ds_write_b64 v13, v[36:37] offset:9632
  s_mov_b32 exec_hi, 0
  ds_write_b64 v13, v[38:39] offset:9648
  s_mov_b64 exec, -1
  v_pk_add_f32 v[80:81], v[64:65], v[44:45] op_sel_hi:[1,0] neg_lo:[0,1] neg_hi:[0,1]
  v_pk_add_f32 v[82:83], v[66:67], v[44:45] op_sel_hi:[1,0] neg_lo:[0,1] neg_hi:[0,1]
  v_pk_add_f32 v[84:85], v[68:69], v[44:45] op_sel_hi:[1,0] neg_lo:[0,1] neg_hi:[0,1]
  v_pk_add_f32 v[86:87], v[70:71], v[44:45] op_sel_hi:[1,0] neg_lo:[0,1] neg_hi:[0,1]
  v_pk_add_f32 v[88:89], v[72:73], v[44:45] op_sel_hi:[1,0] neg_lo:[0,1] neg_hi:[0,1]
  v_pk_add_f32 v[90:91], v[74:75], v[44:45] op_sel_hi:[1,0] neg_lo:[0,1] neg_hi:[0,1]
  v_pk_add_f32 v[92:93], v[76:77], v[44:45] op_sel_hi:[1,0] neg_lo:[0,1] neg_hi:[0,1]
  v_pk_add_f32 v[94:95], v[78:79], v[44:45] op_sel_hi:[1,0] neg_lo:[0,1] neg_hi:[0,1]
  v_cvt_pk_bf16_f32 v48, v80, v81
  v_cvt_pk_bf16_f32 v49, v82, v83
  v_cvt_pk_bf16_f32 v50, v84, v85
  v_cvt_pk_bf16_f32 v51, v86, v87
  v_cvt_pk_bf16_f32 v52, v88, v89
  v_cvt_pk_bf16_f32 v53, v90, v91
  v_cvt_pk_bf16_f32 v54, v92, v93
  v_cvt_pk_bf16_f32 v55, v94, v95
  v_lshlrev_b32 v80, 16, v48
  v_and_b32 v81, 0xffff0000, v48
  v_lshlrev_b32 v82, 16, v49
  v_and_b32 v83, 0xffff0000, v49
  v_lshlrev_b32 v84, 16, v50
  v_and_b32 v85, 0xffff0000, v50
  v_lshlrev_b32 v86, 16, v51
  v_and_b32 v87, 0xffff0000, v51
  v_lshlrev_b32 v88, 16, v52
  v_and_b32 v89, 0xffff0000, v52
  v_lshlrev_b32 v90, 16, v53
  v_and_b32 v91, 0xffff0000, v53
  v_lshlrev_b32 v92, 16, v54
  v_and_b32 v93, 0xffff0000, v54
  v_lshlrev_b32 v94, 16, v55
  v_and_b32 v95, 0xffff0000, v55
  v_pk_mul_f32 v[80:81], v[80:81], v[46:47] op_sel_hi:[1,0]
  v_pk_mul_f32 v[82:83], v[82:83], v[46:47] op_sel_hi:[1,0]
  v_pk_mul_f32 v[84:85], v[84:85], v[46:47] op_sel_hi:[1,0]
  v_pk_mul_f32 v[86:87], v[86:87], v[46:47] op_sel_hi:[1,0]
  v_pk_mul_f32 v[88:89], v[88:89], v[46:47] op_sel_hi:[1,0]
  v_pk_mul_f32 v[90:91], v[90:91], v[46:47] op_sel_hi:[1,0]
  v_pk_mul_f32 v[92:93], v[92:93], v[46:47] op_sel_hi:[1,0]
  v_pk_mul_f32 v[94:95], v[94:95], v[46:47] op_sel_hi:[1,0]
  v_cvt_pk_bf16_f32 v48, v80, v81
  v_cvt_pk_bf16_f32 v49, v82, v83
  v_cvt_pk_bf16_f32 v50, v84, v85
  v_cvt_pk_bf16_f32 v51, v86, v87
  v_cvt_pk_bf16_f32 v52, v88, v89
  v_cvt_pk_bf16_f32 v53, v90, v91
  v_cvt_pk_bf16_f32 v54, v92, v93
  v_cvt_pk_bf16_f32 v55, v94, v95
  s_mov_b64 exec, s[88:89]
  ds_write_b64 v13, v[48:49] offset:7680
  ds_write_b64 v13, v[50:51] offset:7696
  ds_write_b64 v13, v[52:53] offset:7712
  s_mov_b32 exec_hi, 0
  ds_write_b64 v13, v[54:55] offset:7728
  s_mov_b64 exec, -1
  s_waitcnt lgkmcnt(0)
  s_barrier
  ds_read_b128 v[40:43], v18
  v_lshlrev_b32 v80, 16, v48
  v_and_b32 v81, 0xffff0000, v48
  v_lshlrev_b32 v82, 16, v49
  v_and_b32 v83, 0xffff0000, v49
  v_lshlrev_b32 v84, 16, v50
  v_and_b32 v85, 0xffff0000, v50
  v_lshlrev_b32 v86, 16, v51
  v_and_b32 v87, 0xffff0000, v51
  v_lshlrev_b32 v88, 16, v52
  v_and_b32 v89, 0xffff0000, v52
  v_lshlrev_b32 v90, 16, v53
  v_and_b32 v91, 0xffff0000, v53
  v_lshlrev_b32 v92, 16, v54
  v_and_b32 v93, 0xffff0000, v54
  v_lshlrev_b32 v94, 16, v55
  v_and_b32 v95, 0xffff0000, v55
  s_mov_b32 exec_hi, 0xffffff
  s_waitcnt lgkmcnt(0)
  buffer_store_dwordx4 v[40:43], v19, s[16:19], s95 offen sc1
  s_mov_b32 exec_hi, -1
  v_lshlrev_b32 v2, 7, v0
  s_mov_b32 s91, 16384
  s_cmp_lt_i32 s3, 0
  s_cbranch_scc1 L_nokey1
  s_cmp_lg_u32 s44, 0
  s_cbranch_scc1 L_nokey1
  buffer_load_dwordx4 v[32:35], v2, s[16:19], s91 offen sc1
L_nokey1:
  v_pk_add_f32 v[80:81], v[80:81], v[64:65]
  v_pk_add_f32 v[82:83], v[82:83], v[66:67]
  v_pk_add_f32 v[84:85], v[84:85], v[68:69]
  v_pk_add_f32 v[86:87], v[86:87], v[70:71]
  v_pk_add_f32 v[88:89], v[88:89], v[72:73]
  v_pk_add_f32 v[90:91], v[90:91], v[74:75]
  v_pk_add_f32 v[92:93], v[92:93], v[76:77]
  v_pk_add_f32 v[94:95], v[94:95], v[78:79]
  v_cvt_pk_bf16_f32 v56, v80, v81
  v_cvt_pk_bf16_f32 v57, v82, v83
  v_cvt_pk_bf16_f32 v58, v84, v85
  v_cvt_pk_bf16_f32 v59, v86, v87
  v_cvt_pk_bf16_f32 v60, v88, v89
  v_cvt_pk_bf16_f32 v61, v90, v91
  v_cvt_pk_bf16_f32 v62, v92, v93
  v_cvt_pk_bf16_f32 v63, v94, v95
  ds_write_b64 v14, v[56:57] offset:0
  ds_write_b64 v14, v[58:59] offset:16
  ds_write_b64 v14, v[60:61] offset:32
  s_mov_b32 exec_hi, 0
  ds_write_b64 v14, v[62:63] offset:48
  s_mov_b32 exec_hi, -1
  s_mov_b32 s94, 126208
  v_lshlrev_b32 v3, 3, v0
  s_cmp_lt_i32 s3, 0
  s_cbranch_scc1 L_kwait
  v_lshrrev_b32 v8, 4, v0
  v_lshrrev_b32 v9, 2, v0
  v_and_b32 v9, 3, v9
  v_and_b32 v10, 3, v0
  v_lshlrev_b32 v10, 3, v10
  v_lshl_add_u32 v11, v8, 3, v9
  v_lshl_add_u32 v11, v11, 6, v10
  s_lshr_b32 s61, s44, 1
  s_mul_i32 s61, s61, 28672
  s_and_b32 s62, s44, 1
  s_lshl_b32 s62, s62, 5
  s_add_u32 s61, s61, s62
  v_add_u32 v11, s61, v11
  v_lshl_add_u32 v12, v8, 2, v9
  v_mul_u32_u24 v12, 896, v12
  s_mul_i32 s61, s44, 224
  s_add_u32 s61, s61, 149504
  v_add3_u32 v12, v12, v10, s61
  v_subrev_u32 v14, 92160, v12
  s_lshl_b32 s61, s44, 4
  s_add_u32 s61, s61, s94
  v_mov_b32 v26, s61
  v_lshl_add_u32 v24, v0, 2, s94
  v_min_u32 v10, 55, v0
  v_lshlrev_b32 v10, 4, v10
  s_mul_i32 s61, s44, 2112
  s_add_u32 s61, s61, 138240
  v_add_u32 v6, s61, v10
  v_lshrrev_b32 v8, 4, v0
  v_and_b32 v9, 7, v0
  v_mul_u32_u24 v13, 1056, v9
  v_lshl_add_u32 v13, v8, 4, v13
  v_add_u32 v13, 138240, v13
  v_lshlrev_b32 v9, 4, v9
  v_lshl_add_u32 v9, v8, 7, v9
  v_and_b32 v8, 8, v0
  v_lshl_add_u32 v9, v8, 6, v9
  v_lshlrev_b32 v8, 4, v0
  v_add_u32 v8, 126464, v8
  s_lshl_b32 s61, s44, 10
  v_add_u32 v7, s61, v8
  s_mul_i32 s61, s3, 14336
  s_mul_i32 s62, s44, 3584
  s_add_u32 s61, s61, s62
  s_add_u32 s99, s61, 11534336
  s_cmp_eq_u32 s44, 0
  s_cbranch_scc1 L_ksel
  ds_read_b64_tr_b16 v[128:129], v11 offset:0
  ds_read_b64_tr_b16 v[130:131], v11 offset:256
  ds_read_b64_tr_b16 v[132:133], v11 offset:2048
  ds_read_b64_tr_b16 v[134:135], v11 offset:2304
  ds_read_b64_tr_b16 v[136:137], v11 offset:4096
  ds_read_b64_tr_b16 v[138:139], v11 offset:4352
  ds_read_b64_tr_b16 v[140:141], v11 offset:6144
  ds_read_b64_tr_b16 v[142:143], v11 offset:6400
  ds_read_b64_tr_b16 v[144:145], v11 offset:8192
  ds_read_b64_tr_b16 v[146:147], v11 offset:8448
  ds_read_b64_tr_b16 v[148:149], v11 offset:10240
  ds_read_b64_tr_b16 v[150:151], v11 offset:10496
  ds_read_b64_tr_b16 v[152:153], v11 offset:12288
  ds_read_b64_tr_b16 v[154:155], v11 offset:12544
  ds_read_b64_tr_b16 v[156:157], v11 offset:14336
  ds_read_b64_tr_b16 v[158:159], v11 offset:14592
  ds_read_b64_tr_b16 v[160:161], v11 offset:16384
  ds_read_b64_tr_b16 v[162:163], v11 offset:16640
  ds_read_b64_tr_b16 v[164:165], v11 offset:18432
  ds_read_b64_tr_b16 v[166:167], v11 offset:18688
  ds_read_b64_tr_b16 v[168:169], v11 offset:20480
  ds_read_b64_tr_b16 v[170:171], v11 offset:20736
  ds_read_b64_tr_b16 v[172:173], v11 offset:22528
  ds_read_b64_tr_b16 v[174:175], v11 offset:22784
  ds_read_b64_tr_b16 v[176:177], v11 offset:24576
  ds_read_b64_tr_b16 v[178:179], v11 offset:24832
  ds_read_b64_tr_b16 v[180:181], v11 offset:26624
  ds_read_b64_tr_b16 v[182:183], v11 offset:26880
  ds_read_b64_tr_b16 v[64:65], v12 offset:0
  ds_read_b64_tr_b16 v[66:67], v14 offset:0
  ds_read_b64_tr_b16 v[68:69], v12 offset:32
  ds_read_b64_tr_b16 v[70:71], v14 offset:32
  ds_read_b64_tr_b16 v[72:73], v12 offset:64
  ds_read_b64_tr_b16 v[74:75], v14 offset:64
  ds_read_b64_tr_b16 v[76:77], v12 offset:96
  ds_read_b64_tr_b16 v[78:79], v14 offset:96
  ds_read_b64_tr_b16 v[80:81], v12 offset:128
  ds_read_b64_tr_b16 v[82:83], v14 offset:128
  ds_read_b64_tr_b16 v[84:85], v12 offset:160
  ds_read_b64_tr_b16 v[86:87], v14 offset:160
  ds_read_b64_tr_b16 v[88:89], v12 offset:192
  ds_read_b64_tr_b16 v[90:91], v14 offset:192
  s_branch L_selwait
L_ksel:
  s_branch L_kchk
L_kpoll:
  buffer_load_dwordx4 v[32:35], v2, s[16:19], s91 offen sc1
L_kchk:
  s_waitcnt vmcnt(0)
  v_max3_u32 v22, v32, v33, v34
  v_max3_u32 v22, v22, v35, v35
  v_cmp_eq_u32 vcc, -1, v22
  s_cbranch_vccz L_kok
  s_add_u32 s96, s96, 1
  s_cmp_gt_u32 s96, 131072
  s_cbranch_scc1 L_kok
  s_branch L_kpoll
L_kok:
  v_max_u32_dpp v22, v32, v32 row_ror:1 row_mask:0xf bank_mask:0xf bound_ctrl:1
  s_nop 1
  v_max_u32_dpp v22, v22, v22 row_ror:2 row_mask:0xf bank_mask:0xf bound_ctrl:1
  s_nop 1
  v_max_u32_dpp v22, v22, v22 row_ror:4 row_mask:0xf bank_mask:0xf bound_ctrl:1
  s_nop 1
  v_max_u32_dpp v23, v22, v22 row_ror:8 row_mask:0xf bank_mask:0xf bound_ctrl:1
  v_min_u32_dpp v22, v22, v22 row_ror:8 row_mask:0xf bank_mask:0xf bound_ctrl:1
  v_readlane_b32 s64, v23, 0
  v_readlane_b32 s65, v23, 16
  v_readlane_b32 s66, v23, 32
  v_readlane_b32 s67, v23, 48
  v_readlane_b32 s68, v22, 0
  v_readlane_b32 s69, v22, 16
  v_readlane_b32 s70, v22, 32
  v_readlane_b32 s71, v22, 48
  s_max_u32 s64, s64, s65
  s_max_u32 s66, s66, s67
  s_min_u32 s68, s68, s69
  s_min_u32 s70, s70, s71
  s_max_u32 s91, s64, s66
  s_min_u32 s90, s68, s70
  s_min_u32 s91, s91, 0x7fffffff
  s_min_u32 s90, s90, s91
  s_sub_u32 s90, s90, 1
  s_max_i32 s90, s90, 0
L_bisa:
  s_add_u32 s98, s90, s91
  s_lshr_b32 s98, s98, 1
  v_cmp_lt_u32 s[64:65], s98, v32
  v_cmp_lt_u32 s[66:67], s98, v33
  s_bcnt1_i32_b64 s92, s[64:65]
  s_bcnt1_i32_b64 s93, s[66:67]
  s_add_u32 s92, s92, s93
  s_cmp_eq_u32 s92, 8
  s_cbranch_scc1 L_bisdonea
  s_cmp_gt_u32 s92, 8
  s_cselect_b32 s90, s98, s90
  s_cselect_b32 s91, s91, s98
  s_add_u32 s98, s90, s91
  s_lshr_b32 s98, s98, 1
  v_cmp_lt_u32 s[64:65], s98, v32
  v_cmp_lt_u32 s[66:67], s98, v33
  s_bcnt1_i32_b64 s92, s[64:65]
  s_bcnt1_i32_b64 s93, s[66:67]
  s_add_u32 s92, s92, s93
  s_cmp_eq_u32 s92, 8
  s_cbranch_scc1 L_bisdonea
  s_cmp_gt_u32 s92, 8
  s_cselect_b32 s90, s98, s90
  s_cselect_b32 s91, s91, s98
  s_add_u32 s98, s90, s91
  s_lshr_b32 s98, s98, 1
  v_cmp_lt_u32 s[64:65], s98, v32
  v_cmp_lt_u32 s[66:67], s98, v33
  s_bcnt1_i32_b64 s92, s[64:65]
  s_bcnt1_i32_b64 s93, s[66:67]
  s_add_u32 s92, s92, s93
  s_cmp_eq_u32 s92, 8
  s_cbranch_scc1 L_bisdonea
  s_cmp_gt_u32 s92, 8
  s_cselect_b32 s90, s98, s90
  s_cselect_b32 s91, s91, s98
  s_add_u32 s98, s90, s91
  s_lshr_b32 s98, s98, 1
  v_cmp_lt_u32 s[64:65], s98, v32
  v_cmp_lt_u32 s[66:67], s98, v33
  s_bcnt1_i32_b64 s92, s[64:65]
  s_bcnt1_i32_b64 s93, s[66:67]
  s_add_u32 s92, s92, s93
  s_cmp_eq_u32 s92, 8
  s_cbranch_scc1 L_bisdonea
  s_cmp_gt_u32 s92, 8
  s_cselect_b32 s90, s98, s90
  s_cselect_b32 s91, s91, s98
  s_add_u32 s98, s90, s91
  s_lshr_b32 s98, s98, 1
  v_cmp_lt_u32 s[64:65], s98, v32
  v_cmp_lt_u32 s[66:67], s98, v33
  s_bcnt1_i32_b64 s92, s[64:65]
  s_bcnt1_i32_b64 s93, s[66:67]
  s_add_u32 s92, s92, s93
  s_cmp_eq_u32 s92, 8
  s_cbranch_scc1 L_bisdonea
  s_cmp_gt_u32 s92, 8
  s_cselect_b32 s90, s98, s90
  s_cselect_b32 s91, s91, s98
  s_add_u32 s98, s90, s91
  s_lshr_b32 s98, s98, 1
  v_cmp_lt_u32 s[64:65], s98, v32
  v_cmp_lt_u32 s[66:67], s98, v33
  s_bcnt1_i32_b64 s92, s[64:65]
  s_bcnt1_i32_b64 s93, s[66:67]
  s_add_u32 s92, s92, s93
  s_cmp_eq_u32 s92, 8
  s_cbranch_scc1 L_bisdonea
  s_cmp_gt_u32 s92, 8
  s_cselect_b32 s90, s98, s90
  s_cselect_b32 s91, s91, s98
  s_sub_u32 s92, s91, s90
  s_cmp_gt_u32 s92, 1
  s_cbranch_scc1 L_bisa
  s_branch L_topslow
L_bisdonea:
  v_cmp_lt_u32 vcc, s98, v34
  s_add_u32 s98, s98, 1
  s_cbranch_vccnz L_topslow
  s_bcnt1_i32_b64 s92, s[64:65]
  v_mbcnt_lo_u32_b32 v22, s64, 0
  v_mbcnt_lo_u32_b32 v23, s66, 0
  v_mbcnt_hi_u32_b32 v22, s65, v22
  v_mbcnt_hi_u32_b32 v23, s67, v23
  v_add_u32 v4, 1, v3
  v_add_u32 v23, s92, v23
  v_lshl_add_u32 v22, v22, 3, s94
  v_lshl_add_u32 v23, v23, 3, s94
  s_mov_b64 exec, s[64:65]
  ds_write2_b32 v22, v32, v3 offset1:1
  s_mov_b64 exec, s[66:67]
  ds_write2_b32 v23, v33, v4 offset1:1
  s_mov_b64 exec, -1
L_topdone:
  v_mov_b32 v22, s94
  v_mov_b32 v23, s98
  ds_write_b32 v22, v23 offset:64
L_selwait:
  s_waitcnt lgkmcnt(0)
  s_barrier
  ds_read2_b32 v[4:5], v26 offset0:1 offset1:3
  ds_read_b32 v25, v24
  s_mov_b32 s90, 7864320
  s_movk_i32 s91, 896
  s_waitcnt lgkmcnt(1)
  v_and_b32 v4, 511, v4
  v_and_b32 v5, 511, v5
  v_mad_u32_u24 v4, v4, s91, v10
  v_mad_u32_u24 v5, v5, s91, v10
L_gpoll:
  buffer_load_dwordx4 v[32:35], v4, s[16:19], s90 offen sc1
  buffer_load_dwordx4 v[36:39], v5, s[16:19], s90 offen sc1
  s_waitcnt lgkmcnt(0)
  v_readlane_b32 s98, v25, 16
  v_lshlrev_b32 v24, 2, v0
  s_lshl_b32 s92, s3, 7
  s_add_u32 s92, s92, 24576
  v_cmp_le_u32 s[80:81], s98, v47
  s_cmp_lg_u32 s44, 0
  s_cbranch_scc1 L_haveA
  ds_read_b64_tr_b16 v[128:129], v11 offset:0
  ds_read_b64_tr_b16 v[130:131], v11 offset:256
  ds_read_b64_tr_b16 v[132:133], v11 offset:2048
  ds_read_b64_tr_b16 v[134:135], v11 offset:2304
  ds_read_b64_tr_b16 v[136:137], v11 offset:4096
  ds_read_b64_tr_b16 v[138:139], v11 offset:4352
  ds_read_b64_tr_b16 v[140:141], v11 offset:6144
  ds_read_b64_tr_b16 v[142:143], v11 offset:6400
  ds_read_b64_tr_b16 v[144:145], v11 offset:8192
  ds_read_b64_tr_b16 v[146:147], v11 offset:8448
  ds_read_b64_tr_b16 v[148:149], v11 offset:10240
  ds_read_b64_tr_b16 v[150:151], v11 offset:10496
  ds_read_b64_tr_b16 v[152:153], v11 offset:12288
  ds_read_b64_tr_b16 v[154:155], v11 offset:12544
  ds_read_b64_tr_b16 v[156:157], v11 offset:14336
  ds_read_b64_tr_b16 v[158:159], v11 offset:14592
  ds_read_b64_tr_b16 v[160:161], v11 offset:16384
  ds_read_b64_tr_b16 v[162:163], v11 offset:16640
  ds_read_b64_tr_b16 v[164:165], v11 offset:18432
  ds_read_b64_tr_b16 v[166:167], v11 offset:18688
  ds_read_b64_tr_b16 v[168:169], v11 offset:20480
  ds_read_b64_tr_b16 v[170:171], v11 offset:20736
  ds_read_b64_tr_b16 v[172:173], v11 offset:22528
  ds_read_b64_tr_b16 v[174:175], v11 offset:22784
  ds_read_b64_tr_b16 v[176:177], v11 offset:24576
  ds_read_b64_tr_b16 v[178:179], v11 offset:24832
  ds_read_b64_tr_b16 v[180:181], v11 offset:26624
  ds_read_b64_tr_b16 v[182:183], v11 offset:26880
  ds_read_b64_tr_b16 v[64:65], v12 offset:0
  ds_read_b64_tr_b16 v[66:67], v14 offset:0
  ds_read_b64_tr_b16 v[68:69], v12 offset:32
  ds_read_b64_tr_b16 v[70:71], v14 offset:32
  ds_read_b64_tr_b16 v[72:73], v12 offset:64
  ds_read_b64_tr_b16 v[74:75], v14 offset:64
  ds_read_b64_tr_b16 v[76:77], v12 offset:96
  ds_read_b64_tr_b16 v[78:79], v14 offset:96
  ds_read_b64_tr_b16 v[80:81], v12 offset:128
  ds_read_b64_tr_b16 v[82:83], v14 offset:128
  ds_read_b64_tr_b16 v[84:85], v12 offset:160
  ds_read_b64_tr_b16 v[86:87], v14 offset:160
  ds_read_b64_tr_b16 v[88:89], v12 offset:192
  ds_read_b64_tr_b16 v[90:91], v14 offset:192
L_haveA:
  s_waitcnt vmcnt(1)
  ds_write_b128 v6, v[32:35]
  v_max3_u32 v22, v32, v33, v34
  s_waitcnt vmcnt(0)
  ds_write_b128 v6, v[36:39] offset:1056
  v_max3_u32 v22, v22, v35, v36
  v_max3_u32 v22, v22, v37, v38
  v_max_u32 v22, v22, v39
  v_cmp_eq_u32 vcc, -1, v22
  s_cbranch_vccz L_gok
  s_add_u32 s96, s96, 1
  s_cmp_gt_u32 s96, 131072
  s_cbranch_scc1 L_gok
  s_branch L_gpoll
L_gok:
  s_waitcnt lgkmcnt(0)
  s_barrier
  s_cmp_lg_u32 s44, 3
  s_cbranch_scc1 L_nores
  s_mov_b64 exec, 0x1ffff
  buffer_store_dword v25, v24, s[16:19], s92 offen sc1
  s_mov_b64 exec, -1
L_nores:
  ds_read_b128 v[192:195], v13 offset:0
  ds_read_b128 v[196:199], v13 offset:64
  ds_read_b128 v[200:203], v13 offset:128
  ds_read_b128 v[204:207], v13 offset:192
  ds_read_b128 v[208:211], v13 offset:256
  ds_read_b128 v[212:215], v13 offset:320
  ds_read_b128 v[216:219], v13 offset:384
  ds_read_b128 v[220:223], v13 offset:448
  ds_read_b128 v[224:227], v13 offset:512
  ds_read_b128 v[228:231], v13 offset:576
  ds_read_b128 v[232:235], v13 offset:640
  ds_read_b128 v[236:239], v13 offset:704
  ds_read_b128 v[240:243], v13 offset:768
  ds_read_b128 v[244:247], v13 offset:832
  s_waitcnt lgkmcnt(12)
  v_mfma_f32_16x16x32_bf16 v[40:43], v[128:131], v[192:195], 0
  v_mfma_f32_16x16x32_bf16 v[44:47], v[132:135], v[196:199], 0
  s_waitcnt lgkmcnt(10)
  v_mfma_f32_16x16x32_bf16 v[40:43], v[136:139], v[200:203], v[40:43]
  v_mfma_f32_16x16x32_bf16 v[44:47], v[140:143], v[204:207], v[44:47]
  s_waitcnt lgkmcnt(8)
  v_mfma_f32_16x16x32_bf16 v[40:43], v[144:147], v[208:211], v[40:43]
  v_mfma_f32_16x16x32_bf16 v[44:47], v[148:151], v[212:215], v[44:47]
  s_waitcnt lgkmcnt(6)
  v_mfma_f32_16x16x32_bf16 v[40:43], v[152:155], v[216:219], v[40:43]
  v_mfma_f32_16x16x32_bf16 v[44:47], v[156:159], v[220:223], v[44:47]
  s_waitcnt lgkmcnt(4)
  v_mfma_f32_16x16x32_bf16 v[40:43], v[160:163], v[224:227], v[40:43]
  v_mfma_f32_16x16x32_bf16 v[44:47], v[164:167], v[228:231], v[44:47]
  s_waitcnt lgkmcnt(2)
  v_mfma_f32_16x16x32_bf16 v[40:43], v[168:171], v[232:235], v[40:43]
  v_mfma_f32_16x16x32_bf16 v[44:47], v[172:175], v[236:239], v[44:47]
  s_waitcnt lgkmcnt(0)
  v_mfma_f32_16x16x32_bf16 v[40:43], v[176:179], v[240:243], v[40:43]
  v_mfma_f32_16x16x32_bf16 v[44:47], v[180:183], v[244:247], v[44:47]
  s_nop 7
  v_add_f32 v40, v40, v44
  v_add_f32 v41, v41, v45
  v_add_f32 v42, v42, v46
  v_add_f32 v43, v43, v47
  v_cvt_pk_bf16_f32 v44, v40, v41
  v_cvt_pk_bf16_f32 v45, v42, v43
  s_cmp_ge_u32 s44, 2
  s_cbranch_scc1 L_nosilu
  v_lshlrev_b32 v48, 16, v44
  v_and_b32 v49, 0xffff0000, v44
  v_lshlrev_b32 v50, 16, v45
  v_and_b32 v51, 0xffff0000, v45
  v_mul_f32 v52, 0xbfb8aa3b, v48
  v_mul_f32 v53, 0xbfb8aa3b, v49
  v_mul_f32 v54, 0xbfb8aa3b, v50
  v_mul_f32 v55, 0xbfb8aa3b, v51
  v_exp_f32 v52, v52
  v_exp_f32 v53, v53
  v_exp_f32 v54, v54
  v_exp_f32 v55, v55
  v_add_f32 v52, 1.0, v52
  v_add_f32 v53, 1.0, v53
  v_add_f32 v54, 1.0, v54
  v_add_f32 v55, 1.0, v55
  v_rcp_f32 v52, v52
  v_rcp_f32 v53, v53
  v_rcp_f32 v54, v54
  v_rcp_f32 v55, v55
  v_mul_f32 v48, v48, v52
  v_mul_f32 v49, v49, v53
  v_mul_f32 v50, v50, v54
  v_mul_f32 v51, v51, v55
  v_cvt_pk_bf16_f32 v44, v48, v49
  v_cvt_pk_bf16_f32 v45, v50, v51
L_nosilu:
  v_lshlrev_b32 v40, 16, v44
  v_and_b32 v41, 0xffff0000, v44
  v_lshlrev_b32 v42, 16, v45
  v_and_b32 v43, 0xffff0000, v45
  ds_write_b128 v7, v[40:43]
  s_waitcnt lgkmcnt(0)
  s_barrier
  ds_read_b128 v[48:51], v8
  ds_read_b128 v[56:59], v8 offset:2048
  ds_read_b128 v[52:55], v8 offset:1024
  ds_read_b128 v[60:63], v8 offset:3072
  s_waitcnt lgkmcnt(2)
  v_pk_mul_f32 v[48:49], v[48:49], v[56:57]
  v_pk_mul_f32 v[50:51], v[50:51], v[58:59]
  s_waitcnt lgkmcnt(0)
  v_pk_mul_f32 v[52:53], v[52:53], v[60:61]
  v_pk_mul_f32 v[54:55], v[54:55], v[62:63]
  v_cvt_pk_bf16_f32 v44, v48, v49
  v_cvt_pk_bf16_f32 v45, v50, v51
  v_cvt_pk_bf16_f32 v46, v52, v53
  v_cvt_pk_bf16_f32 v47, v54, v55
  s_mov_b32 vcc_lo, 0xff00ff00
  s_mov_b32 vcc_hi, 0xff00ff00
  v_mfma_f32_16x16x32_bf16 v[128:131], v[64:67], v[44:47], 0
  v_mfma_f32_16x16x32_bf16 v[132:135], v[68:71], v[44:47], 0
  v_mfma_f32_16x16x32_bf16 v[136:139], v[72:75], v[44:47], 0
  v_mfma_f32_16x16x32_bf16 v[140:143], v[76:79], v[44:47], 0
  v_mfma_f32_16x16x32_bf16 v[144:147], v[80:83], v[44:47], 0
  v_mfma_f32_16x16x32_bf16 v[148:151], v[84:87], v[44:47], 0
  s_nop 3
  v_cndmask_b32 v128, v128, v132, vcc
  v_cndmask_b32 v129, v129, v133, vcc
  v_cndmask_b32 v130, v130, v134, vcc
  v_cndmask_b32 v131, v131, v135, vcc
  buffer_store_dwordx4 v[128:131], v9, s[16:19], s99 offen offset:0 sc1
  v_mfma_f32_16x16x32_bf16 v[152:155], v[88:91], v[44:47], 0
  v_cndmask_b32 v136, v136, v140, vcc
  v_cndmask_b32 v137, v137, v141, vcc
  v_cndmask_b32 v138, v138, v142, vcc
  v_cndmask_b32 v139, v139, v143, vcc
  buffer_store_dwordx4 v[136:139], v9, s[16:19], s99 offen offset:1024 sc1
  v_cndmask_b32 v144, v144, v148, vcc
  v_cndmask_b32 v145, v145, v149, vcc
  v_cndmask_b32 v146, v146, v150, vcc
  v_cndmask_b32 v147, v147, v151, vcc
  buffer_store_dwordx4 v[144:147], v9, s[16:19], s99 offen offset:2048 sc1
  s_mov_b32 exec_lo, 0x00ff00ff
  s_mov_b32 exec_hi, 0x00ff00ff
  buffer_store_dwordx4 v[152:155], v9, s[16:19], s99 offen offset:3072 sc1
  s_mov_b64 exec, -1
  s_branch L_noffn
L_kwait:
  s_waitcnt lgkmcnt(0)
  s_barrier
  ds_read_b128 v[48:51], v15
  ds_read_b128 v[52:55], v16
  v_lshrrev_b32_e64 v22, v20, s88
  v_lshrrev_b32_e64 v23, v21, s88
  v_and_b32 v22, 1, v22
  v_and_b32 v23, 1, v23
  v_cmp_eq_u32 s[70:71], 0, v22
  v_cmp_eq_u32 vcc, 0, v23
  s_waitcnt lgkmcnt(0)
  s_mov_b64 exec, s[70:71]
  s_cbranch_execz L_out1e
  buffer_store_dwordx4 v[48:51], v116, s[24:27], s7 offen sc1
L_out1e:
  s_and_b32 vcc_hi, vcc_hi, 0xffff
  s_mov_b64 exec, vcc
  s_cbranch_execz L_out2e
  buffer_store_dwordx4 v[52:55], v117, s[24:27], s7 offen sc1
L_out2e:
  s_mov_b64 exec, -1
  s_mul_i32 s61, s50, 9363
  s_lshr_b32 s61, s61, 16
  s_mul_i32 s61, s61, 7
  s_sub_u32 s61, s50, s61
  s_mul_i32 s62, s51, 7
  s_add_u32 s61, s61, s62
  s_lshl_b32 s61, s61, 7
  s_add_u32 s90, s61, 24576
  v_and_b32 v2, 7, v0
  v_lshlrev_b32 v3, 3, v2
  v_lshrrev_b32 v5, 3, v0
  v_mul_u32_u24 v5, 14336, v5
  v_lshl_add_u32 v5, v2, 4, v5
  v_lshrrev_b32 v6, 4, v0
  s_lshl_b32 s61, s4, 3
  v_lshl_add_u32 v6, v6, 1, s61
  s_movk_i32 s91, 896
  s_mov_b32 s92, 8388608
  s_mov_b32 s93, 7864320
  s_waitcnt vmcnt(0)
L_respoll:
  buffer_load_dwordx2 v[12:13], v3, s[16:19], s90 offen sc1
  buffer_load_dword v14, v31, s[16:19], s90 offen offset:64 sc1
  s_waitcnt vmcnt(0)
  v_max3_u32 v22, v12, v13, v14
  v_cmp_eq_u32 vcc, -1, v22
  s_cbranch_vccz L_resok
  s_add_u32 s96, s96, 1
  s_cmp_gt_u32 s96, 131072
  s_cbranch_scc1 L_resok
  s_sleep 2
  s_branch L_respoll
L_resok:
  v_cmp_le_u32 s[80:81], v14, v47
  s_cmp_lt_i32 s4, 0
  s_cbranch_scc1 L_nored
  s_cmp_lg_u32 s44, 0
  s_cbranch_scc1 L_nored
  v_and_b32 v7, 0x7ff, v12
  v_sub_u32 v7, 2047, v7
  v_and_b32 v13, 511, v13
  v_mad_u32_u24 v13, v13, s91, v6
  v_mad_u32_u24 v6, v7, s91, v6
  buffer_load_ushort v8, v13, s[16:19], s92 offen sc1
  buffer_load_ushort v9, v13, s[16:19], s93 offen sc1
L_nored:
L_noffn:
  s_cmp_lt_i32 s3, 0
  s_cselect_b32 s61, s88, -1
  s_orn2_b32 s80, s80, s61
  ds_read_b128 v[48:51], v15
  ds_read_b128 v[52:55], v16
  v_lshrrev_b32_e64 v22, v20, s80
  v_lshrrev_b32_e64 v23, v21, s80
  v_and_b32 v22, 1, v22
  v_and_b32 v23, 1, v23
  v_cmp_eq_u32 s[70:71], 0, v22
  v_cmp_eq_u32 vcc, 0, v23
  s_waitcnt lgkmcnt(0)
  s_mov_b64 exec, s[70:71]
  s_cbranch_execz L_out1
  buffer_store_dwordx4 v[48:51], v116, s[24:27], s7 offen
L_out1:
  s_and_b32 vcc_hi, vcc_hi, 0xffff
  s_mov_b64 exec, vcc
  s_cbranch_execz L_out2
  buffer_store_dwordx4 v[52:55], v117, s[24:27], s7 offen
L_out2:
  s_mov_b64 exec, -1
  s_cmp_lt_i32 s4, 0
  s_cbranch_scc1 L_fin
  s_cmp_lg_u32 s44, 0
  s_cbranch_scc1 L_fin
  s_lshl_b32 s90, s4, 7
  s_add_u32 s90, s90, 11534336
  v_lshlrev_b32 v10, 1, v12
  v_and_b32 v10, 0xffff0000, v10
  v_ashrrev_i32 v11, 31, v10
  v_not_b32 v11, v11
  v_or_b32 v11, 0x80000000, v11
  v_xor_b32 v10, v10, v11
  v_and_b32 v10, 0xffff0000, v10
  v_mul_f32 v10, 0xbfb8aa3b, v10
  v_exp_f32 v10, v10
  s_nop 0
  v_add_f32 v10, 1.0, v10
  v_rcp_f32 v10, v10
  s_nop 0
  v_cvt_pk_bf16_f32 v10, v10, v10
  v_and_b32 v10, 0xffff0000, v10
L_rpoll:
  s_waitcnt vmcnt(0)
  v_max_u32 v11, v8, v9
  v_cmp_eq_u32 vcc, 0xffff, v11
  s_cbranch_vccz L_rok
  s_add_u32 s96, s96, 1
  s_cmp_gt_u32 s96, 131072
  s_cbranch_scc1 L_rok
  buffer_load_ushort v8, v13, s[16:19], s92 offen sc1
  buffer_load_ushort v9, v13, s[16:19], s93 offen sc1
  s_branch L_rpoll
L_rok:
  v_lshlrev_b32 v8, 16, v8
  v_lshlrev_b32 v9, 16, v9
L_ypoll:
  s_add_u32 s61, s90, 0
  buffer_load_dwordx4 v[32:35], v5, s[16:19], s61 offen sc1
  s_add_u32 s61, s90, 114688
  buffer_load_dwordx4 v[36:39], v5, s[16:19], s61 offen sc1
  s_add_u32 s61, s90, 229376
  buffer_load_dwordx4 v[40:43], v5, s[16:19], s61 offen sc1
  s_add_u32 s61, s90, 344064
  buffer_load_dwordx4 v[44:47], v5, s[16:19], s61 offen sc1
  s_add_u32 s61, s90, 458752
  buffer_load_dwordx4 v[48:51], v5, s[16:19], s61 offen sc1
  s_add_u32 s61, s90, 573440
  buffer_load_dwordx4 v[52:55], v5, s[16:19], s61 offen sc1
  s_add_u32 s61, s90, 688128
  buffer_load_dwordx4 v[56:59], v5, s[16:19], s61 offen sc1
  s_waitcnt vmcnt(0)
L_ychk:
  v_max3_u32 v22, v32, v33, v34
  v_max3_u32 v22, v22, v35, v36
  v_max3_u32 v22, v22, v37, v38
  v_max3_u32 v22, v22, v39, v40
  v_max3_u32 v22, v22, v41, v42
  v_max3_u32 v22, v22, v43, v44
  v_max3_u32 v22, v22, v45, v46
  v_max3_u32 v22, v22, v47, v48
  v_max3_u32 v22, v22, v49, v50
  v_max3_u32 v22, v22, v51, v52
  v_max3_u32 v22, v22, v53, v54
  v_max3_u32 v22, v22, v55, v56
  v_max3_u32 v22, v22, v57, v58
  v_max3_u32 v22, v22, v59, v59
  v_cmp_eq_u32 vcc, -1, v22
  s_cbranch_vccz L_yok
  s_add_u32 s96, s96, 1
  s_cmp_gt_u32 s96, 131072
  s_cbranch_scc1 L_yok
  s_branch L_ypoll
L_yok:
  v_pk_add_f32 v[32:33], v[32:33], v[36:37]
  v_pk_add_f32 v[34:35], v[34:35], v[38:39]
  v_pk_add_f32 v[40:41], v[40:41], v[44:45]
  v_pk_add_f32 v[42:43], v[42:43], v[46:47]
  v_pk_add_f32 v[48:49], v[48:49], v[52:53]
  v_pk_add_f32 v[50:51], v[50:51], v[54:55]
  v_pk_add_f32 v[32:33], v[32:33], v[40:41]
  v_pk_add_f32 v[34:35], v[34:35], v[42:43]
  v_pk_add_f32 v[48:49], v[48:49], v[56:57]
  v_pk_add_f32 v[50:51], v[50:51], v[58:59]
  v_pk_add_f32 v[32:33], v[32:33], v[48:49]
  v_pk_add_f32 v[34:35], v[34:35], v[50:51]
  s_nop 0
  v_add_f32_dpp v36, v32, v32 row_ror:8 row_mask:0xf bank_mask:0xf bound_ctrl:1
  v_add_f32_dpp v37, v33, v33 row_ror:8 row_mask:0xf bank_mask:0xf bound_ctrl:1
  v_add_f32_dpp v38, v34, v34 row_ror:8 row_mask:0xf bank_mask:0xf bound_ctrl:1
  v_add_f32_dpp v39, v35, v35 row_ror:8 row_mask:0xf bank_mask:0xf bound_ctrl:1
  v_permlane16_swap_b32 v36, v37
  s_nop 0
  v_permlane16_swap_b32 v38, v39
  v_add_f32 v36, v36, v37
  v_add_f32 v38, v38, v39
  s_nop 1
  v_permlane32_swap_b32 v36, v38
  v_add_f32 v36, v36, v38
  v_cvt_pk_bf16_f32 v36, v36, v36
  v_and_b32 v36, 0xffff0000, v36
  v_mul_f32 v36, v36, v10
  v_cvt_pk_bf16_f32 v36, v36, v36
  v_and_b32 v36, 0xffff0000, v36
  v_add_f32 v36, v36, v9
  v_cvt_pk_bf16_f32 v36, v36, v36
  v_and_b32 v36, 0xffff0000, v36
  v_add_f32 v36, v36, v8
  v_cvt_pk_bf16_f32 v36, v36, v36
  s_mov_b32 exec_lo, 0x00ff00ff
  s_mov_b32 exec_hi, 0x00ff00ff
  buffer_store_short v36, v6, s[24:27], 0 offen
  s_mov_b64 exec, -1
L_fin:
L_end:
  s_endpgm
L_topslow:
  s_mov_b32 s91, 16384
L_kpoll2:
  buffer_load_dwordx4 v[32:35], v2, s[16:19], s91 offen sc1
  buffer_load_dwordx4 v[36:39], v2, s[16:19], s91 offen offset:16 sc1
  s_waitcnt vmcnt(0)
  v_max3_u32 v22, v32, v33, v34
  v_max3_u32 v22, v22, v35, v36
  v_max3_u32 v22, v22, v37, v38
  v_max3_u32 v22, v22, v39, v39
  v_cmp_eq_u32 vcc, -1, v22
  s_cbranch_vccz L_kok2
  s_add_u32 s96, s96, 1
  s_cmp_gt_u32 s96, 131072
  s_cbranch_scc1 L_kok2
  s_branch L_kpoll2
L_kok2:
  s_mov_b32 s90, 0
  s_mov_b32 s91, 0x80000000
L_bisb:
  s_add_u32 s98, s90, s91
  s_lshr_b32 s98, s98, 1
  v_cmp_le_u32 s[64:65], s98, v32
  v_cmp_le_u32 s[66:67], s98, v33
  v_cmp_le_u32 s[68:69], s98, v34
  v_cmp_le_u32 s[70:71], s98, v35
  v_cmp_le_u32 s[72:73], s98, v36
  v_cmp_le_u32 s[74:75], s98, v37
  v_cmp_le_u32 s[76:77], s98, v38
  v_cmp_le_u32 s[78:79], s98, v39
  s_bcnt1_i32_b64 s92, s[64:65]
  s_bcnt1_i32_b64 s93, s[66:67]
  s_add_u32 s92, s92, s93
  s_bcnt1_i32_b64 s93, s[68:69]
  s_add_u32 s92, s92, s93
  s_bcnt1_i32_b64 s93, s[70:71]
  s_add_u32 s92, s92, s93
  s_bcnt1_i32_b64 s93, s[72:73]
  s_add_u32 s92, s92, s93
  s_bcnt1_i32_b64 s93, s[74:75]
  s_add_u32 s92, s92, s93
  s_bcnt1_i32_b64 s93, s[76:77]
  s_add_u32 s92, s92, s93
  s_bcnt1_i32_b64 s93, s[78:79]
  s_add_u32 s92, s92, s93
  s_cmp_eq_u32 s92, 8
  s_cbranch_scc1 L_bisdoneb
  s_cmp_eq_u32 s98, s90
  s_cbranch_scc1 L_bisdoneb
  s_cmp_gt_u32 s92, 8
  s_cselect_b32 s90, s98, s90
  s_cselect_b32 s91, s91, s98
  s_branch L_bisb
L_bisdoneb:
  s_mov_b32 s92, 0
  v_mbcnt_lo_u32_b32 v22, s64, 0
  v_mbcnt_hi_u32_b32 v22, s65, v22
  v_add_u32 v22, s92, v22
  v_min_u32 v22, 7, v22
  v_lshl_add_u32 v22, v22, 3, s94
  v_add_u32 v23, 0, v3
  s_mov_b64 exec, s[64:65]
  ds_write2_b32 v22, v32, v23 offset1:1
  s_mov_b64 exec, -1
  s_bcnt1_i32_b64 s93, s[64:65]
  s_add_u32 s92, s92, s93
  v_mbcnt_lo_u32_b32 v22, s66, 0
  v_mbcnt_hi_u32_b32 v22, s67, v22
  v_add_u32 v22, s92, v22
  v_min_u32 v22, 7, v22
  v_lshl_add_u32 v22, v22, 3, s94
  v_add_u32 v23, 1, v3
  s_mov_b64 exec, s[66:67]
  ds_write2_b32 v22, v33, v23 offset1:1
  s_mov_b64 exec, -1
  s_bcnt1_i32_b64 s93, s[66:67]
  s_add_u32 s92, s92, s93
  v_mbcnt_lo_u32_b32 v22, s68, 0
  v_mbcnt_hi_u32_b32 v22, s69, v22
  v_add_u32 v22, s92, v22
  v_min_u32 v22, 7, v22
  v_lshl_add_u32 v22, v22, 3, s94
  v_add_u32 v23, 2, v3
  s_mov_b64 exec, s[68:69]
  ds_write2_b32 v22, v34, v23 offset1:1
  s_mov_b64 exec, -1
  s_bcnt1_i32_b64 s93, s[68:69]
  s_add_u32 s92, s92, s93
  v_mbcnt_lo_u32_b32 v22, s70, 0
  v_mbcnt_hi_u32_b32 v22, s71, v22
  v_add_u32 v22, s92, v22
  v_min_u32 v22, 7, v22
  v_lshl_add_u32 v22, v22, 3, s94
  v_add_u32 v23, 3, v3
  s_mov_b64 exec, s[70:71]
  ds_write2_b32 v22, v35, v23 offset1:1
  s_mov_b64 exec, -1
  s_bcnt1_i32_b64 s93, s[70:71]
  s_add_u32 s92, s92, s93
  v_mbcnt_lo_u32_b32 v22, s72, 0
  v_mbcnt_hi_u32_b32 v22, s73, v22
  v_add_u32 v22, s92, v22
  v_min_u32 v22, 7, v22
  v_lshl_add_u32 v22, v22, 3, s94
  v_add_u32 v23, 4, v3
  s_mov_b64 exec, s[72:73]
  ds_write2_b32 v22, v36, v23 offset1:1
  s_mov_b64 exec, -1
  s_bcnt1_i32_b64 s93, s[72:73]
  s_add_u32 s92, s92, s93
  v_mbcnt_lo_u32_b32 v22, s74, 0
  v_mbcnt_hi_u32_b32 v22, s75, v22
  v_add_u32 v22, s92, v22
  v_min_u32 v22, 7, v22
  v_lshl_add_u32 v22, v22, 3, s94
  v_add_u32 v23, 5, v3
  s_mov_b64 exec, s[74:75]
  ds_write2_b32 v22, v37, v23 offset1:1
  s_mov_b64 exec, -1
  s_bcnt1_i32_b64 s93, s[74:75]
  s_add_u32 s92, s92, s93
  v_mbcnt_lo_u32_b32 v22, s76, 0
  v_mbcnt_hi_u32_b32 v22, s77, v22
  v_add_u32 v22, s92, v22
  v_min_u32 v22, 7, v22
  v_lshl_add_u32 v22, v22, 3, s94
  v_add_u32 v23, 6, v3
  s_mov_b64 exec, s[76:77]
  ds_write2_b32 v22, v38, v23 offset1:1
  s_mov_b64 exec, -1
  s_bcnt1_i32_b64 s93, s[76:77]
  s_add_u32 s92, s92, s93
  v_mbcnt_lo_u32_b32 v22, s78, 0
  v_mbcnt_hi_u32_b32 v22, s79, v22
  v_add_u32 v22, s92, v22
  v_min_u32 v22, 7, v22
  v_lshl_add_u32 v22, v22, 3, s94
  v_add_u32 v23, 7, v3
  s_mov_b64 exec, s[78:79]
  ds_write2_b32 v22, v39, v23 offset1:1
  s_mov_b64 exec, -1
  s_branch L_topdone
L_bad:
  v_mov_b32 v8, 1.0
  s_nop 0
  v_cndmask_b32 v221, v8, v221, s[86:87]
  s_mov_b32 exec_lo, 0
  ds_write_b32 v10, v8 offset:3076
  ds_write_b32 v11, v8 offset:3076
  ds_write_b32 v12, v8 offset:3076
  s_mov_b32 exec_lo, -1
  s_branch L_badok
L_kvr1:
  s_add_u32 s96, s96, 1
  s_cmp_gt_u32 s96, 131072
  s_cbranch_scc1 L_kvd1
  buffer_load_dwordx4 v[224:227], v1, s[16:19], s65 offen offset:0 sc1
  buffer_load_dwordx4 v[228:231], v1, s[16:19], s65 offen offset:1024 sc1
  buffer_load_dwordx4 v[232:235], v1, s[16:19], s65 offen offset:2048 sc1
  buffer_load_dwordx4 v[236:239], v1, s[16:19], s65 offen offset:3072 sc1
  buffer_load_dword v15, v6, s[16:19], s65 offen sc1
  s_waitcnt vmcnt(0)
  s_branch L_kvc1
L_kvpr:
  s_add_u32 s96, s96, 1
  s_cmp_gt_u32 s96, 131072
  s_cbranch_scc1 L_kvok
  buffer_load_dword v3, v2, s[16:19], s82 offen sc1
  s_waitcnt vmcnt(0)
  s_branch L_kvpoll
L_redo:
  s_mov_b32 s97, 1
  s_waitcnt vmcnt(0) lgkmcnt(0)
  s_barrier
  s_mov_b32 s95, 16
  s_lshl_b32 s63, s45, 6
  s_add_u32 s63, s63, s44
  s_mul_i32 s63, s63, 4352
  s_add_u32 s63, s63, 1048576
  v_mov_b32 v8, 0xff800000
  v_mov_b32 v9, 0xff800000
  v_mov_b32 v10, 0xff800000
  v_mov_b32 v11, 0xff800000
L_redo_loop:
  buffer_load_dwordx4 v[224:227], v1, s[16:19], s63 offen sc1
  buffer_load_dwordx4 v[228:231], v1, s[16:19], s63 offen offset:1024 sc1
  s_add_u32 s63, s63, 17408
  s_waitcnt vmcnt(0)
  v_mfma_f32_32x32x16_bf16 v[32:47], v[224:227], v[128:131], 0
  v_mfma_f32_32x32x16_bf16 v[32:47], v[228:231], v[132:135], v[32:47]
  s_nop 11
  v_max3_f32 v22, v32, v33, v34
  v_max3_f32 v23, v35, v36, v37
  v_max3_f32 v22, v22, v38, v39
  v_max3_f32 v23, v23, v40, v41
  v_max3_f32 v22, v22, v42, v43
  v_max3_f32 v23, v23, v44, v45
  v_max3_f32 v22, v22, v46, v47
  v_max_f32 v22, v22, v23
  v_mov_b32 v23, v22
  s_nop 1
  v_permlane32_swap_b32 v22, v23
  v_max_f32 v22, v22, v23
  v_max_f32 v8, v8, v22
  v_mfma_f32_32x32x16_bf16 v[32:47], v[224:227], v[136:139], 0
  v_mfma_f32_32x32x16_bf16 v[32:47], v[228:231], v[140:143], v[32:47]
  s_nop 11
  v_max3_f32 v22, v32, v33, v34
  s_nop 10
  v_max3_f32 v23, v35, v36, v37
  v_max3_f32 v22, v22, v38, v39
  v_max3_f32 v23, v23, v40, v41
  v_max3_f32 v22, v22, v42, v43
  v_max3_f32 v23, v23, v44, v45
  v_max3_f32 v22, v22, v46, v47
  v_max_f32 v22, v22, v23
  v_mov_b32 v23, v22
  s_nop 1
  v_permlane32_swap_b32 v22, v23
  v_max_f32 v22, v22, v23
  v_max_f32 v9, v9, v22
  v_mfma_f32_32x32x16_bf16 v[32:47], v[224:227], v[144:147], 0
  v_mfma_f32_32x32x16_bf16 v[32:47], v[228:231], v[148:151], v[32:47]
  s_nop 11
  v_max3_f32 v22, v32, v33, v34
  v_max3_f32 v23, v35, v36, v37
  s_nop 9
  v_max3_f32 v22, v22, v38, v39
  v_max3_f32 v23, v23, v40, v41
  v_max3_f32 v22, v22, v42, v43
  v_max3_f32 v23, v23, v44, v45
  v_max3_f32 v22, v22, v46, v47
  v_max_f32 v22, v22, v23
  v_mov_b32 v23, v22
  s_nop 1
  v_permlane32_swap_b32 v22, v23
  v_max_f32 v22, v22, v23
  v_max_f32 v10, v10, v22
  v_mfma_f32_32x32x16_bf16 v[32:47], v[224:227], v[152:155], 0
  v_mfma_f32_32x32x16_bf16 v[32:47], v[228:231], v[156:159], v[32:47]
  s_nop 11
  v_max3_f32 v22, v32, v33, v34
  v_max3_f32 v23, v35, v36, v37
  v_max3_f32 v22, v22, v38, v39
  s_nop 8
  v_max3_f32 v23, v23, v40, v41
  v_max3_f32 v22, v22, v42, v43
  v_max3_f32 v23, v23, v44, v45
  v_max3_f32 v22, v22, v46, v47
  v_max_f32 v22, v22, v23
  v_mov_b32 v23, v22
  s_nop 1
  v_permlane32_swap_b32 v22, v23
  v_max_f32 v22, v22, v23
  v_max_f32 v11, v11, v22
  s_sub_u32 s95, s95, 1
  s_cmp_lg_u32 s95, 0
  s_cbranch_scc1 L_redo_loop
  s_add_u32 s61, s44, 1
  s_and_b32 s61, s61, 3
  s_lshl_b32 s61, s61, 10
  s_add_u32 s61, s61, 114688
  v_lshl_add_u32 v12, v0, 2, s61
  s_lshl_b32 s62, s44, 8
  v_add_u32 v16, s62, v12
  ds_write_b32 v16, v8
  s_add_u32 s61, s44, 2
  s_and_b32 s61, s61, 3
  s_lshl_b32 s61, s61, 10
  s_add_u32 s61, s61, 114688
  v_lshl_add_u32 v13, v0, 2, s61
  s_lshl_b32 s62, s44, 8
  v_add_u32 v16, s62, v13
  ds_write_b32 v16, v9
  s_add_u32 s61, s44, 3
  s_and_b32 s61, s61, 3
  s_lshl_b32 s61, s61, 10
  s_add_u32 s61, s61, 114688
  v_lshl_add_u32 v14, v0, 2, s61
  s_lshl_b32 s62, s44, 8
  v_add_u32 v16, s62, v14
  ds_write_b32 v16, v10
  s_add_u32 s61, s44, 4
  s_and_b32 s61, s61, 3
  s_lshl_b32 s61, s61, 10
  s_add_u32 s61, s61, 114688
  v_lshl_add_u32 v15, v0, 2, s61
  s_lshl_b32 s62, s44, 8
  v_add_u32 v16, s62, v15
  ds_write_b32 v16, v11
  s_waitcnt lgkmcnt(0)
  s_barrier
  ds_read_b32 v16, v12 offset:0
  ds_read_b32 v17, v12 offset:256
  ds_read_b32 v18, v12 offset:512
  ds_read_b32 v19, v12 offset:768
  s_waitcnt lgkmcnt(0)
  v_max3_f32 v16, v16, v17, v18
  v_max_f32 v16, v16, v19
  v_lshlrev_b32 v17, 16, v134
  v_and_b32 v18, 0xffff0000, v134
  v_lshlrev_b32 v19, 16, v135
  v_add_f32 v18, v18, v19
  v_add_f32 v17, v17, v18
  v_sub_f32 v22, v16, v17
  v_cvt_pk_bf16_f32 v23, -v22, -v22
  v_and_b32 v23, 0xffff0000, v23
  v_sub_f32_e64 v24, -v22, v23
  v_cvt_pk_bf16_f32 v25, v24, v24
  v_and_b32 v25, 0xffff0000, v25
  v_sub_f32 v24, v24, v25
  v_cvt_pk_bf16_f32 v23, v23, v25
  v_cvt_pk_bf16_f32 v24, v24, 0
  v_cndmask_b32 v134, v23, v134, s[86:87]
  v_cndmask_b32 v135, v24, v135, s[86:87]
  ds_read_b32 v16, v13 offset:0
  ds_read_b32 v17, v13 offset:256
  ds_read_b32 v18, v13 offset:512
  ds_read_b32 v19, v13 offset:768
  s_waitcnt lgkmcnt(0)
  v_max3_f32 v16, v16, v17, v18
  v_max_f32 v16, v16, v19
  v_lshlrev_b32 v17, 16, v142
  v_and_b32 v18, 0xffff0000, v142
  v_lshlrev_b32 v19, 16, v143
  v_add_f32 v18, v18, v19
  v_add_f32 v17, v17, v18
  v_sub_f32 v22, v16, v17
  v_cvt_pk_bf16_f32 v23, -v22, -v22
  v_and_b32 v23, 0xffff0000, v23
  v_sub_f32_e64 v24, -v22, v23
  v_cvt_pk_bf16_f32 v25, v24, v24
  v_and_b32 v25, 0xffff0000, v25
  v_sub_f32 v24, v24, v25
  v_cvt_pk_bf16_f32 v23, v23, v25
  v_cvt_pk_bf16_f32 v24, v24, 0
  v_cndmask_b32 v142, v23, v142, s[86:87]
  v_cndmask_b32 v143, v24, v143, s[86:87]
  ds_read_b32 v16, v14 offset:0
  ds_read_b32 v17, v14 offset:256
  ds_read_b32 v18, v14 offset:512
  ds_read_b32 v19, v14 offset:768
  s_waitcnt lgkmcnt(0)
  v_max3_f32 v16, v16, v17, v18
  v_max_f32 v16, v16, v19
  v_lshlrev_b32 v17, 16, v150
  v_and_b32 v18, 0xffff0000, v150
  v_lshlrev_b32 v19, 16, v151
  v_add_f32 v18, v18, v19
  v_add_f32 v17, v17, v18
  v_sub_f32 v22, v16, v17
  v_cvt_pk_bf16_f32 v23, -v22, -v22
  v_and_b32 v23, 0xffff0000, v23
  v_sub_f32_e64 v24, -v22, v23
  v_cvt_pk_bf16_f32 v25, v24, v24
  v_and_b32 v25, 0xffff0000, v25
  v_sub_f32 v24, v24, v25
  v_cvt_pk_bf16_f32 v23, v23, v25
  v_cvt_pk_bf16_f32 v24, v24, 0
  v_cndmask_b32 v150, v23, v150, s[86:87]
  v_cndmask_b32 v151, v24, v151, s[86:87]
  ds_read_b32 v16, v15 offset:0
  ds_read_b32 v17, v15 offset:256
  ds_read_b32 v18, v15 offset:512
  ds_read_b32 v19, v15 offset:768
  s_waitcnt lgkmcnt(0)
  v_max3_f32 v16, v16, v17, v18
  v_max_f32 v16, v16, v19
  v_lshlrev_b32 v17, 16, v158
  v_and_b32 v18, 0xffff0000, v158
  v_lshlrev_b32 v19, 16, v159
  v_add_f32 v18, v18, v19
  v_add_f32 v17, v17, v18
  v_sub_f32 v22, v16, v17
  v_cvt_pk_bf16_f32 v23, -v22, -v22
  v_and_b32 v23, 0xffff0000, v23
  v_sub_f32_e64 v24, -v22, v23
  v_cvt_pk_bf16_f32 v25, v24, v24
  v_and_b32 v25, 0xffff0000, v25
  v_sub_f32 v24, v24, v25
  v_cvt_pk_bf16_f32 v23, v23, v25
  v_cvt_pk_bf16_f32 v24, v24, 0
  v_cndmask_b32 v158, v23, v158, s[86:87]
  v_cndmask_b32 v159, v24, v159, s[86:87]
  buffer_load_dwordx4 v[240:243], v1, s[16:19], s64 offen offset:0 sc1
  buffer_load_dwordx4 v[244:247], v1, s[16:19], s64 offen offset:1024 sc1
  buffer_load_dwordx4 v[248:251], v1, s[16:19], s64 offen offset:2048 sc1
  buffer_load_dwordx4 v[252:255], v1, s[16:19], s64 offen offset:3072 sc1
  buffer_load_dwordx4 v[224:227], v1, s[16:19], s65 offen offset:0 sc1
  buffer_load_dwordx4 v[228:231], v1, s[16:19], s65 offen offset:1024 sc1
  buffer_load_dwordx4 v[232:235], v1, s[16:19], s65 offen offset:2048 sc1
  buffer_load_dwordx4 v[236:239], v1, s[16:19], s65 offen offset:3072 sc1
  buffer_load_dword v15, v6, s[16:19], s65 offen sc1
  s_waitcnt vmcnt(0)
  s_barrier
  v_mfma_f32_32x32x16_bf16 v[32:47], v[240:243], v[152:155], 0
  v_mfma_f32_32x32x16_bf16 v[32:47], v[244:247], v[156:159], v[32:47]
  s_nop 11
  s_branch L_att
L_helper:
  s_waitcnt lgkmcnt(0)
  s_load_dword s49, s[84:85], 0
  s_lshl_b32 s47, s95, 5
  s_lshl_b32 s61, s94, 3
  s_add_u32 s47, s47, s61
  s_lshr_b32 s61, s50, 2
  s_add_u32 s47, s47, s61
  s_mov_b32 s60, 0x3f803f80
  s_mov_b32 s86, -1
  s_mov_b32 s87, 0
  s_mov_b32 s96, 0
  s_mov_b32 s97, 0
  s_lshr_b32 s61, s50, 2
  s_sub_u32 s61, s50, s61
  s_sub_u32 s61, s61, 1
  s_mul_i32 s62, s51, 7
  s_add_u32 s3, s61, s62
  s_cmp_lt_u32 s50, 10
  s_cselect_b32 s3, s3, -1
  s_cmp_eq_u32 s48, 0
  s_cselect_b32 s3, -1, s3
  s_mul_i32 s62, s51, 14
  s_sub_u32 s61, s50, 10
  s_add_u32 s4, s61, s62
  s_cmp_lt_u32 s61, 14
  s_cselect_b32 s4, s4, -1
  s_mul_i32 s7, s47, 28672
  s_mul_i32 s61, s48, 224
  s_add_u32 s7, s7, s61
  s_mov_b32 s16, s84
  s_mov_b32 s17, s85
  s_mov_b32 s18, 16777216
  s_mov_b32 s19, 0x20000
  s_mov_b32 s20, s68
  s_mov_b32 s21, s69
  s_mov_b32 s22, 401408
  s_mov_b32 s23, 0x20000
  s_mov_b32 s24, s80
  s_mov_b32 s25, s81
  s_mov_b32 s26, 1835008
  s_mov_b32 s27, 0x20000
  s_mov_b32 s28, s74
  s_mov_b32 s29, s75
  s_mov_b32 s30, 1605632
  s_mov_b32 s31, 0x20000
  s_mov_b32 s32, s76
  s_mov_b32 s33, s77
  s_mov_b32 s34, 1605632
  s_mov_b32 s35, 0x20000
  s_mov_b32 s36, s78
  s_mov_b32 s37, s79
  s_mov_b32 s38, 1605632
  s_mov_b32 s39, 0x20000
  s_mov_b32 s40, s72
  s_mov_b32 s41, s73
  s_mov_b32 s42, 896
  s_mov_b32 s43, 0x20000
  s_waitcnt lgkmcnt(0)
  s_mul_i32 s49, s49, 0x19660d
  s_add_u32 s49, s49, 0x3c6ef35f
  v_mov_b32 v30, s49
  s_getpc_b64 s[52:53]
L_pc:
  s_sub_u32 s52, s52, L_pc-sequential_preLN__mha_block__moe_arch_mod__prompt_kernel
  s_subb_u32 s53, s53, 0
  s_mul_i32 s61, s50, 1408
  v_min_u32 v25, 10, v0
  v_lshl_add_u32 v25, v25, 7, s61
  v_min_u32 v25, L_last-sequential_preLN__mha_block__moe_arch_mod__prompt_kernel, v25
  v_lshlrev_b32 v1, 4, v0
  v_mov_b32 v4, -1
  v_mov_b32 v5, -1
  v_mov_b32 v6, -1
  v_mov_b32 v7, -1
  v_mov_b32 v31, 0
  v_lshrrev_b32 v22, 4, v0
  v_lshrrev_b32 v23, 2, v0
  v_sub_u32 v23, v23, v22
  v_and_b32 v23, 3, v23
  v_mul_u32_u24 v23, 56, v23
  v_mul_u32_u24 v22, 896, v22
  v_add_u32 v22, v22, v23
  v_and_b32 v23, 3, v0
  v_lshlrev_b32 v23, 4, v23
  v_min_u32 v23, 40, v23
  v_add_u32 v2, v22, v23
  v_lshlrev_b32 v3, 7, v0
  v_mul_u32_u24 v22, 4682, v0
  v_lshrrev_b32 v22, 16, v22
  v_mul_u32_u24 v27, 14, v22
  v_sub_u32 v23, v0, v27
  v_mul_u32_u24 v27, 896, v22
  v_lshl_add_u32 v8, v23, 4, v27
  v_lshrrev_b32 v22, 2, v0
  v_min_u32 v22, 13, v22
  v_mul_u32_u24 v22, 3584, v22
  v_and_b32 v23, 3, v0
  v_lshl_add_u32 v22, v23, 7, v22
  s_mul_i32 s90, s51, 200704
  s_mul_i32 s62, s50, 6272
  s_add_u32 s90, s90, s62
  s_mul_i32 s91, s50, 50176
  s_mul_i32 s62, s51, 448
  s_and_b32 s62, s62, -128
  s_add_u32 s91, s91, s62
  s_lshr_b32 s92, s50, 2
  s_mul_i32 s92, s92, 7
  s_lshr_b32 s92, s92, 1
  s_mul_i32 s94, s48, 224
  s_mul_i32 s95, s50, 7
  s_lshr_b32 s95, s95, 3
  s_add_u32 s95, s95, 0
  s_lshl_b32 s61, s46, 6
  s_add_u32 s61, s61, s45
  s_lshl_b32 s61, s61, 11
  s_add_u32 s64, s61, 5767168
  s_add_u32 s65, s64, 32768
  s_add_u32 s66, s65, 32768
  s_add_u32 s67, s66, 32768
  s_lshl_b32 s61, s47, 2
  s_add_u32 s61, s61, s48
  s_lshl_b32 s61, s61, 9
  s_add_u32 s72, s61, 131072
  s_lshl_b32 s62, s47, 7
  s_add_u32 s73, s62, 16384
  s_cmp_eq_u32 s48, 0
  s_cselect_b32 s73, s73, 2130706432
  s_mul_i32 s61, s3, 14336
  s_add_u32 s74, s61, 11534336
  s_add_u32 s75, s74, 4096
  s_add_u32 s76, s75, 4096
  s_add_u32 s77, s76, 4096
  s_lshl_b32 s61, s2, 2
  s_add_u32 s78, s61, 12288
  s_lshl_b32 s61, s47, 1
  s_and_b32 s62, 0, 1
  s_add_u32 s61, s61, s62
  s_mul_i32 s61, s61, 3584
  s_mul_i32 s62, s48, 224
  s_add_u32 s61, s61, s62
  s_lshr_b32 s62, 0, 1
  s_mul_i32 s62, s62, 524288
  s_add_u32 s61, s61, s62
  s_add_u32 s68, s61, 7864320
  s_lshl_b32 s61, s47, 1
  s_and_b32 s62, 1, 1
  s_add_u32 s61, s61, s62
  s_mul_i32 s61, s61, 3584
  s_mul_i32 s62, s48, 224
  s_add_u32 s61, s61, s62
  s_lshr_b32 s62, 1, 1
  s_mul_i32 s62, s62, 524288
  s_add_u32 s61, s61, s62
  s_add_u32 s69, s61, 7864320
  s_lshl_b32 s61, s47, 1
  s_and_b32 s62, 2, 1
  s_add_u32 s61, s61, s62
  s_mul_i32 s61, s61, 3584
  s_mul_i32 s62, s48, 224
  s_add_u32 s61, s61, s62
  s_lshr_b32 s62, 2, 1
  s_mul_i32 s62, s62, 524288
  s_add_u32 s61, s61, s62
  s_add_u32 s70, s61, 7864320
  s_lshl_b32 s61, s47, 1
  s_and_b32 s62, 3, 1
  s_add_u32 s61, s61, s62
  s_mul_i32 s61, s61, 3584
  s_mul_i32 s62, s48, 224
  s_add_u32 s61, s61, s62
  s_lshr_b32 s62, 3, 1
  s_mul_i32 s62, s62, 524288
  s_add_u32 s61, s61, s62
  s_add_u32 s71, s61, 7864320
  s_barrier
  s_barrier
  s_barrier
  s_barrier
  global_load_dword v26, v25, s[52:53]
  s_barrier
  s_barrier
  s_barrier
  s_barrier
  s_barrier
  s_barrier
  s_barrier
  s_barrier
  s_barrier
  s_barrier
  s_mul_i32 s5, s92, 14336
  s_add_u32 s5, s5, s94
  s_lshl_b32 s6, s92, 12
  s_add_u32 m0, s6, 0
  s_add_u32 s61, s5, 0
  buffer_load_dwordx4 v2, s[20:23], s61 offen lds
  s_add_u32 m0, s6, 1024
  s_add_u32 s61, s5, 3584
  buffer_load_dwordx4 v2, s[20:23], s61 offen lds
  s_add_u32 m0, s6, 2048
  s_add_u32 s61, s5, 7168
  buffer_load_dwordx4 v2, s[20:23], s61 offen lds
  s_add_u32 m0, s6, 3072
  s_add_u32 s61, s5, 10752
  buffer_load_dwordx4 v2, s[20:23], s61 offen lds
  buffer_store_dwordx4 v[4:7], v1, s[16:19], s64 offen offset:0 sc1
  s_cmp_lt_i32 s3, 0
  s_cbranch_scc1 L_h_y0
  buffer_store_dwordx4 v[4:7], v1, s[16:19], s74 offen offset:0 sc1
L_h_y0:
  s_cmp_lg_u32 s95, 0
  s_cbranch_scc1 L_h_t0
  buffer_load_dword v20, v3, s[36:39], s90 offen
  buffer_load_dword v20, v22, s[28:31], s91 offen
  buffer_load_dword v20, v22, s[32:35], s91 offen
L_h_t0:
  s_waitcnt vmcnt(8)
  s_add_u32 s92, s92, 1
  s_cmp_eq_u32 s92, 28
  s_cselect_b32 s92, 0, s92
  s_mul_i32 s5, s92, 14336
  s_add_u32 s5, s5, s94
  s_lshl_b32 s6, s92, 12
  s_add_u32 m0, s6, 0
  s_add_u32 s61, s5, 0
  buffer_load_dwordx4 v2, s[20:23], s61 offen lds
  s_add_u32 m0, s6, 1024
  s_add_u32 s61, s5, 3584
  buffer_load_dwordx4 v2, s[20:23], s61 offen lds
  s_add_u32 m0, s6, 2048
  s_add_u32 s61, s5, 7168
  buffer_load_dwordx4 v2, s[20:23], s61 offen lds
  s_add_u32 m0, s6, 3072
  s_add_u32 s61, s5, 10752
  buffer_load_dwordx4 v2, s[20:23], s61 offen lds
  buffer_store_dwordx4 v[4:7], v1, s[16:19], s64 offen offset:1024 sc1
  s_cmp_lt_i32 s3, 0
  s_cbranch_scc1 L_h_y1
  buffer_store_dwordx4 v[4:7], v1, s[16:19], s74 offen offset:1024 sc1
L_h_y1:
  s_cmp_lg_u32 s95, 1
  s_cbranch_scc1 L_h_t1
  buffer_load_dword v20, v3, s[36:39], s90 offen
  buffer_load_dword v20, v22, s[28:31], s91 offen
  buffer_load_dword v20, v22, s[32:35], s91 offen
L_h_t1:
  s_waitcnt vmcnt(8)
  s_add_u32 s92, s92, 1
  s_cmp_eq_u32 s92, 28
  s_cselect_b32 s92, 0, s92
  s_mul_i32 s5, s92, 14336
  s_add_u32 s5, s5, s94
  s_lshl_b32 s6, s92, 12
  s_add_u32 m0, s6, 0
  s_add_u32 s61, s5, 0
  buffer_load_dwordx4 v2, s[20:23], s61 offen lds
  s_add_u32 m0, s6, 1024
  s_add_u32 s61, s5, 3584
  buffer_load_dwordx4 v2, s[20:23], s61 offen lds
  s_add_u32 m0, s6, 2048
  s_add_u32 s61, s5, 7168
  buffer_load_dwordx4 v2, s[20:23], s61 offen lds
  s_add_u32 m0, s6, 3072
  s_add_u32 s61, s5, 10752
  buffer_load_dwordx4 v2, s[20:23], s61 offen lds
  buffer_store_dwordx4 v[4:7], v1, s[16:19], s65 offen offset:0 sc1
  s_cmp_lt_i32 s3, 0
  s_cbranch_scc1 L_h_y2
  buffer_store_dwordx4 v[4:7], v1, s[16:19], s74 offen offset:2048 sc1
L_h_y2:
  s_cmp_lg_u32 s95, 2
  s_cbranch_scc1 L_h_t2
  buffer_load_dword v20, v3, s[36:39], s90 offen
  buffer_load_dword v20, v22, s[28:31], s91 offen
  buffer_load_dword v20, v22, s[32:35], s91 offen
L_h_t2:
  s_waitcnt vmcnt(8)
  s_add_u32 s92, s92, 1
  s_cmp_eq_u32 s92, 28
  s_cselect_b32 s92, 0, s92
  s_mul_i32 s5, s92, 14336
  s_add_u32 s5, s5, s94
  s_lshl_b32 s6, s92, 12
  s_add_u32 m0, s6, 0
  s_add_u32 s61, s5, 0
  buffer_load_dwordx4 v2, s[20:23], s61 offen lds
  s_add_u32 m0, s6, 1024
  s_add_u32 s61, s5, 3584
  buffer_load_dwordx4 v2, s[20:23], s61 offen lds
  s_add_u32 m0, s6, 2048
  s_add_u32 s61, s5, 7168
  buffer_load_dwordx4 v2, s[20:23], s61 offen lds
  s_add_u32 m0, s6, 3072
  s_add_u32 s61, s5, 10752
  buffer_load_dwordx4 v2, s[20:23], s61 offen lds
  buffer_store_dwordx4 v[4:7], v1, s[16:19], s65 offen offset:1024 sc1
  s_cmp_lt_i32 s3, 0
  s_cbranch_scc1 L_h_y3
  buffer_store_dwordx4 v[4:7], v1, s[16:19], s74 offen offset:3072 sc1
L_h_y3:
  s_cmp_lg_u32 s95, 3
  s_cbranch_scc1 L_h_t3
  buffer_load_dword v20, v3, s[36:39], s90 offen
  buffer_load_dword v20, v22, s[28:31], s91 offen
  buffer_load_dword v20, v22, s[32:35], s91 offen
L_h_t3:
  s_waitcnt vmcnt(8)
  s_add_u32 s92, s92, 1
  s_cmp_eq_u32 s92, 28
  s_cselect_b32 s92, 0, s92
  s_mul_i32 s5, s92, 14336
  s_add_u32 s5, s5, s94
  s_lshl_b32 s6, s92, 12
  s_add_u32 m0, s6, 0
  s_add_u32 s61, s5, 0
  buffer_load_dwordx4 v2, s[20:23], s61 offen lds
  s_add_u32 m0, s6, 1024
  s_add_u32 s61, s5, 3584
  buffer_load_dwordx4 v2, s[20:23], s61 offen lds
  s_add_u32 m0, s6, 2048
  s_add_u32 s61, s5, 7168
  buffer_load_dwordx4 v2, s[20:23], s61 offen lds
  s_add_u32 m0, s6, 3072
  s_add_u32 s61, s5, 10752
  buffer_load_dwordx4 v2, s[20:23], s61 offen lds
  buffer_store_dwordx4 v[4:7], v1, s[16:19], s66 offen offset:0 sc1
  s_cmp_lt_i32 s3, 0
  s_cbranch_scc1 L_h_y4
  buffer_store_dwordx4 v[4:7], v1, s[16:19], s75 offen offset:0 sc1
L_h_y4:
  s_cmp_lg_u32 s95, 4
  s_cbranch_scc1 L_h_t4
  buffer_load_dword v20, v3, s[36:39], s90 offen
  buffer_load_dword v20, v22, s[28:31], s91 offen
  buffer_load_dword v20, v22, s[32:35], s91 offen
L_h_t4:
  s_waitcnt vmcnt(8)
  s_add_u32 s92, s92, 1
  s_cmp_eq_u32 s92, 28
  s_cselect_b32 s92, 0, s92
  s_mul_i32 s5, s92, 14336
  s_add_u32 s5, s5, s94
  s_lshl_b32 s6, s92, 12
  s_add_u32 m0, s6, 0
  s_add_u32 s61, s5, 0
  buffer_load_dwordx4 v2, s[20:23], s61 offen lds
  s_add_u32 m0, s6, 1024
  s_add_u32 s61, s5, 3584
  buffer_load_dwordx4 v2, s[20:23], s61 offen lds
  s_add_u32 m0, s6, 2048
  s_add_u32 s61, s5, 7168
  buffer_load_dwordx4 v2, s[20:23], s61 offen lds
  s_add_u32 m0, s6, 3072
  s_add_u32 s61, s5, 10752
  buffer_load_dwordx4 v2, s[20:23], s61 offen lds
  buffer_store_dwordx4 v[4:7], v1, s[16:19], s66 offen offset:1024 sc1
  s_cmp_lt_i32 s3, 0
  s_cbranch_scc1 L_h_y5
  buffer_store_dwordx4 v[4:7], v1, s[16:19], s75 offen offset:1024 sc1
L_h_y5:
  s_cmp_lg_u32 s95, 5
  s_cbranch_scc1 L_h_t5
  buffer_load_dword v20, v3, s[36:39], s90 offen
  buffer_load_dword v20, v22, s[28:31], s91 offen
  buffer_load_dword v20, v22, s[32:35], s91 offen
L_h_t5:
  s_waitcnt vmcnt(8)
  s_add_u32 s92, s92, 1
  s_cmp_eq_u32 s92, 28
  s_cselect_b32 s92, 0, s92
  s_mul_i32 s5, s92, 14336
  s_add_u32 s5, s5, s94
  s_lshl_b32 s6, s92, 12
  s_add_u32 m0, s6, 0
  s_add_u32 s61, s5, 0
  buffer_load_dwordx4 v2, s[20:23], s61 offen lds
  s_add_u32 m0, s6, 1024
  s_add_u32 s61, s5, 3584
  buffer_load_dwordx4 v2, s[20:23], s61 offen lds
  s_add_u32 m0, s6, 2048
  s_add_u32 s61, s5, 7168
  buffer_load_dwordx4 v2, s[20:23], s61 offen lds
  s_add_u32 m0, s6, 3072
  s_add_u32 s61, s5, 10752
  buffer_load_dwordx4 v2, s[20:23], s61 offen lds
  buffer_store_dwordx4 v[4:7], v1, s[16:19], s67 offen offset:0 sc1
  s_cmp_lt_i32 s3, 0
  s_cbranch_scc1 L_h_y6
  buffer_store_dwordx4 v[4:7], v1, s[16:19], s75 offen offset:2048 sc1
L_h_y6:
  s_cmp_lg_u32 s95, 6
  s_cbranch_scc1 L_h_t6
  buffer_load_dword v20, v3, s[36:39], s90 offen
  buffer_load_dword v20, v22, s[28:31], s91 offen
  buffer_load_dword v20, v22, s[32:35], s91 offen
L_h_t6:
  s_waitcnt vmcnt(8)
  s_add_u32 s92, s92, 1
  s_cmp_eq_u32 s92, 28
  s_cselect_b32 s92, 0, s92
  s_mul_i32 s5, s92, 14336
  s_add_u32 s5, s5, s94
  s_lshl_b32 s6, s92, 12
  s_add_u32 m0, s6, 0
  s_add_u32 s61, s5, 0
  buffer_load_dwordx4 v2, s[20:23], s61 offen lds
  s_add_u32 m0, s6, 1024
  s_add_u32 s61, s5, 3584
  buffer_load_dwordx4 v2, s[20:23], s61 offen lds
  s_add_u32 m0, s6, 2048
  s_add_u32 s61, s5, 7168
  buffer_load_dwordx4 v2, s[20:23], s61 offen lds
  s_add_u32 m0, s6, 3072
  s_add_u32 s61, s5, 10752
  buffer_load_dwordx4 v2, s[20:23], s61 offen lds
  buffer_store_dwordx4 v[4:7], v1, s[16:19], s67 offen offset:1024 sc1
  s_cmp_lt_i32 s3, 0
  s_cbranch_scc1 L_h_y7
  buffer_store_dwordx4 v[4:7], v1, s[16:19], s75 offen offset:3072 sc1
L_h_y7:
  s_cmp_lg_u32 s95, 7
  s_cbranch_scc1 L_h_t7
  buffer_load_dword v20, v3, s[36:39], s90 offen
  buffer_load_dword v20, v22, s[28:31], s91 offen
  buffer_load_dword v20, v22, s[32:35], s91 offen
L_h_t7:
  s_waitcnt vmcnt(8)
  s_add_u32 s92, s92, 1
  s_cmp_eq_u32 s92, 28
  s_cselect_b32 s92, 0, s92
  s_mul_i32 s5, s92, 14336
  s_add_u32 s5, s5, s94
  s_lshl_b32 s6, s92, 12
  s_add_u32 m0, s6, 0
  s_add_u32 s61, s5, 0
  buffer_load_dwordx4 v2, s[20:23], s61 offen lds
  s_add_u32 m0, s6, 1024
  s_add_u32 s61, s5, 3584
  buffer_load_dwordx4 v2, s[20:23], s61 offen lds
  s_add_u32 m0, s6, 2048
  s_add_u32 s61, s5, 7168
  buffer_load_dwordx4 v2, s[20:23], s61 offen lds
  s_add_u32 m0, s6, 3072
  s_add_u32 s61, s5, 10752
  buffer_load_dwordx4 v2, s[20:23], s61 offen lds
  s_mov_b32 exec_hi, 0xffffff
  buffer_store_dwordx4 v[4:7], v8, s[16:19], s68 offen offset:0 sc1
  s_mov_b32 exec_hi, -1
  s_cmp_lt_i32 s3, 0
  s_cbranch_scc1 L_h_y8
  buffer_store_dwordx4 v[4:7], v1, s[16:19], s76 offen offset:0 sc1
L_h_y8:
  s_cmp_lg_u32 s95, 8
  s_cbranch_scc1 L_h_t8
  buffer_load_dword v20, v3, s[36:39], s90 offen
  buffer_load_dword v20, v22, s[28:31], s91 offen
  buffer_load_dword v20, v22, s[32:35], s91 offen
L_h_t8:
  s_waitcnt vmcnt(8)
  s_add_u32 s92, s92, 1
  s_cmp_eq_u32 s92, 28
  s_cselect_b32 s92, 0, s92
  s_mul_i32 s5, s92, 14336
  s_add_u32 s5, s5, s94
  s_lshl_b32 s6, s92, 12
  s_add_u32 m0, s6, 0
  s_add_u32 s61, s5, 0
  buffer_load_dwordx4 v2, s[20:23], s61 offen lds
  s_add_u32 m0, s6, 1024
  s_add_u32 s61, s5, 3584
  buffer_load_dwordx4 v2, s[20:23], s61 offen lds
  s_add_u32 m0, s6, 2048
  s_add_u32 s61, s5, 7168
  buffer_load_dwordx4 v2, s[20:23], s61 offen lds
  s_add_u32 m0, s6, 3072
  s_add_u32 s61, s5, 10752
  buffer_load_dwordx4 v2, s[20:23], s61 offen lds
  s_mov_b32 exec_hi, 0xffffff
  buffer_store_dwordx4 v[4:7], v8, s[16:19], s69 offen offset:0 sc1
  s_mov_b32 exec_hi, -1
  s_cmp_lt_i32 s3, 0
  s_cbranch_scc1 L_h_y9
  buffer_store_dwordx4 v[4:7], v1, s[16:19], s76 offen offset:1024 sc1
L_h_y9:
  s_cmp_lg_u32 s95, 9
  s_cbranch_scc1 L_h_t9
  buffer_load_dword v20, v3, s[36:39], s90 offen
  buffer_load_dword v20, v22, s[28:31], s91 offen
  buffer_load_dword v20, v22, s[32:35], s91 offen
L_h_t9:
  s_waitcnt vmcnt(8)
  s_add_u32 s92, s92, 1
  s_cmp_eq_u32 s92, 28
  s_cselect_b32 s92, 0, s92
  s_mul_i32 s5, s92, 14336
  s_add_u32 s5, s5, s94
  s_lshl_b32 s6, s92, 12
  s_add_u32 m0, s6, 0
  s_add_u32 s61, s5, 0
  buffer_load_dwordx4 v2, s[20:23], s61 offen lds
  s_add_u32 m0, s6, 1024
  s_add_u32 s61, s5, 3584
  buffer_load_dwordx4 v2, s[20:23], s61 offen lds
  s_add_u32 m0, s6, 2048
  s_add_u32 s61, s5, 7168
  buffer_load_dwordx4 v2, s[20:23], s61 offen lds
  s_add_u32 m0, s6, 3072
  s_add_u32 s61, s5, 10752
  buffer_load_dwordx4 v2, s[20:23], s61 offen lds
  s_mov_b32 exec_hi, 0xffffff
  buffer_store_dwordx4 v[4:7], v8, s[16:19], s70 offen offset:0 sc1
  s_mov_b32 exec_hi, -1
  s_cmp_lt_i32 s3, 0
  s_cbranch_scc1 L_h_y10
  buffer_store_dwordx4 v[4:7], v1, s[16:19], s76 offen offset:2048 sc1
L_h_y10:
  s_cmp_lg_u32 s95, 10
  s_cbranch_scc1 L_h_t10
  buffer_load_dword v20, v3, s[36:39], s90 offen
  buffer_load_dword v20, v22, s[28:31], s91 offen
  buffer_load_dword v20, v22, s[32:35], s91 offen
L_h_t10:
  s_waitcnt vmcnt(8)
  s_add_u32 s92, s92, 1
  s_cmp_eq_u32 s92, 28
  s_cselect_b32 s92, 0, s92
  s_mul_i32 s5, s92, 14336
  s_add_u32 s5, s5, s94
  s_lshl_b32 s6, s92, 12
  s_add_u32 m0, s6, 0
  s_add_u32 s61, s5, 0
  buffer_load_dwordx4 v2, s[20:23], s61 offen lds
  s_add_u32 m0, s6, 1024
  s_add_u32 s61, s5, 3584
  buffer_load_dwordx4 v2, s[20:23], s61 offen lds
  s_add_u32 m0, s6, 2048
  s_add_u32 s61, s5, 7168
  buffer_load_dwordx4 v2, s[20:23], s61 offen lds
  s_add_u32 m0, s6, 3072
  s_add_u32 s61, s5, 10752
  buffer_load_dwordx4 v2, s[20:23], s61 offen lds
  s_mov_b32 exec_hi, 0xffffff
  buffer_store_dwordx4 v[4:7], v8, s[16:19], s71 offen offset:0 sc1
  s_mov_b32 exec_hi, -1
  s_cmp_lt_i32 s3, 0
  s_cbranch_scc1 L_h_y11
  buffer_store_dwordx4 v[4:7], v1, s[16:19], s76 offen offset:3072 sc1
L_h_y11:
  s_cmp_lg_u32 s95, 11
  s_cbranch_scc1 L_h_t11
  buffer_load_dword v20, v3, s[36:39], s90 offen
  buffer_load_dword v20, v22, s[28:31], s91 offen
  buffer_load_dword v20, v22, s[32:35], s91 offen
L_h_t11:
  s_waitcnt vmcnt(8)
  s_add_u32 s92, s92, 1
  s_cmp_eq_u32 s92, 28
  s_cselect_b32 s92, 0, s92
  s_mul_i32 s5, s92, 14336
  s_add_u32 s5, s5, s94
  s_lshl_b32 s6, s92, 12
  s_add_u32 m0, s6, 0
  s_add_u32 s61, s5, 0
  buffer_load_dwordx4 v2, s[20:23], s61 offen lds
  s_add_u32 m0, s6, 1024
  s_add_u32 s61, s5, 3584
  buffer_load_dwordx4 v2, s[20:23], s61 offen lds
  s_add_u32 m0, s6, 2048
  s_add_u32 s61, s5, 7168
  buffer_load_dwordx4 v2, s[20:23], s61 offen lds
  s_add_u32 m0, s6, 3072
  s_add_u32 s61, s5, 10752
  buffer_load_dwordx4 v2, s[20:23], s61 offen lds
  s_mov_b32 exec_hi, 0
  buffer_store_dwordx4 v[4:7], v1, s[16:19], s72 offen offset:0 sc1
  s_mov_b64 exec, 3
  buffer_store_dwordx4 v[4:7], v1, s[16:19], s73 offen offset:0 sc1
  s_mov_b64 exec, -1
  s_cmp_lt_i32 s3, 0
  s_cbranch_scc1 L_h_y12
  buffer_store_dwordx4 v[4:7], v1, s[16:19], s77 offen offset:0 sc1
L_h_y12:
  s_cmp_lg_u32 s95, 12
  s_cbranch_scc1 L_h_t12
  buffer_load_dword v20, v3, s[36:39], s90 offen
  buffer_load_dword v20, v22, s[28:31], s91 offen
  buffer_load_dword v20, v22, s[32:35], s91 offen
L_h_t12:
  s_waitcnt vmcnt(8)
  s_add_u32 s92, s92, 1
  s_cmp_eq_u32 s92, 28
  s_cselect_b32 s92, 0, s92
  s_mul_i32 s5, s92, 14336
  s_add_u32 s5, s5, s94
  s_lshl_b32 s6, s92, 12
  s_add_u32 m0, s6, 0
  s_add_u32 s61, s5, 0
  buffer_load_dwordx4 v2, s[20:23], s61 offen lds
  s_add_u32 m0, s6, 1024
  s_add_u32 s61, s5, 3584
  buffer_load_dwordx4 v2, s[20:23], s61 offen lds
  s_add_u32 m0, s6, 2048
  s_add_u32 s61, s5, 7168
  buffer_load_dwordx4 v2, s[20:23], s61 offen lds
  s_add_u32 m0, s6, 3072
  s_add_u32 s61, s5, 10752
  buffer_load_dwordx4 v2, s[20:23], s61 offen lds
  s_getreg_b32 s61, hwreg(HW_REG_XCC_ID)
  v_mov_b32 v21, s61
  s_mov_b64 exec, 1
  buffer_store_dword v21, v31, s[16:19], s78 offen offset:2048 sc1
  s_mov_b64 exec, -1
  s_cmp_lt_i32 s3, 0
  s_cbranch_scc1 L_h_y13
  buffer_store_dwordx4 v[4:7], v1, s[16:19], s77 offen offset:1024 sc1
  s_lshl_b32 s61, s3, 7
  s_add_u32 s61, s61, 24576
  s_mov_b64 exec, 0xff
  buffer_store_dwordx4 v[4:7], v1, s[16:19], s61 offen offset:0 sc1
  s_mov_b64 exec, -1
L_h_y13:
  s_cmp_lg_u32 s95, 13
  s_cbranch_scc1 L_h_t13
  buffer_load_dword v20, v3, s[36:39], s90 offen
  buffer_load_dword v20, v22, s[28:31], s91 offen
  buffer_load_dword v20, v22, s[32:35], s91 offen
L_h_t13:
  s_waitcnt vmcnt(8)
  s_add_u32 s92, s92, 1
  s_cmp_eq_u32 s92, 28
  s_cselect_b32 s92, 0, s92
  s_mul_i32 s5, s92, 14336
  s_add_u32 s5, s5, s94
  s_lshl_b32 s6, s92, 12
  s_add_u32 m0, s6, 0
  s_add_u32 s61, s5, 0
  buffer_load_dwordx4 v2, s[20:23], s61 offen lds
  s_add_u32 m0, s6, 1024
  s_add_u32 s61, s5, 3584
  buffer_load_dwordx4 v2, s[20:23], s61 offen lds
  s_add_u32 m0, s6, 2048
  s_add_u32 s61, s5, 7168
  buffer_load_dwordx4 v2, s[20:23], s61 offen lds
  s_add_u32 m0, s6, 3072
  s_add_u32 s61, s5, 10752
  buffer_load_dwordx4 v2, s[20:23], s61 offen lds
  s_cmp_lg_u32 s95, 14
  s_cbranch_scc1 L_h_t14
  buffer_load_dword v20, v3, s[36:39], s90 offen
  buffer_load_dword v20, v22, s[28:31], s91 offen
  buffer_load_dword v20, v22, s[32:35], s91 offen
L_h_t14:
  s_waitcnt vmcnt(8)
  s_add_u32 s92, s92, 1
  s_cmp_eq_u32 s92, 28
  s_cselect_b32 s92, 0, s92
  s_mul_i32 s5, s92, 14336
  s_add_u32 s5, s5, s94
  s_lshl_b32 s6, s92, 12
  s_add_u32 m0, s6, 0
  s_add_u32 s61, s5, 0
  buffer_load_dwordx4 v2, s[20:23], s61 offen lds
  s_add_u32 m0, s6, 1024
  s_add_u32 s61, s5, 3584
  buffer_load_dwordx4 v2, s[20:23], s61 offen lds
  s_add_u32 m0, s6, 2048
  s_add_u32 s61, s5, 7168
  buffer_load_dwordx4 v2, s[20:23], s61 offen lds
  s_add_u32 m0, s6, 3072
  s_add_u32 s61, s5, 10752
  buffer_load_dwordx4 v2, s[20:23], s61 offen lds
  s_cmp_lg_u32 s95, 15
  s_cbranch_scc1 L_h_t15
  buffer_load_dword v20, v3, s[36:39], s90 offen
  buffer_load_dword v20, v22, s[28:31], s91 offen
  buffer_load_dword v20, v22, s[32:35], s91 offen
L_h_t15:
  s_waitcnt vmcnt(8)
  s_add_u32 s92, s92, 1
  s_cmp_eq_u32 s92, 28
  s_cselect_b32 s92, 0, s92
  s_mov_b64 exec, 1
  buffer_store_dword v30, v31, s[16:19], s78 offen sc1
  s_mov_b64 exec, -1
  s_mul_i32 s5, s92, 14336
  s_add_u32 s5, s5, s94
  s_lshl_b32 s6, s92, 12
  s_add_u32 m0, s6, 0
  s_add_u32 s61, s5, 0
  buffer_load_dwordx4 v2, s[20:23], s61 offen lds
  s_add_u32 m0, s6, 1024
  s_add_u32 s61, s5, 3584
  buffer_load_dwordx4 v2, s[20:23], s61 offen lds
  s_add_u32 m0, s6, 2048
  s_add_u32 s61, s5, 7168
  buffer_load_dwordx4 v2, s[20:23], s61 offen lds
  s_add_u32 m0, s6, 3072
  s_add_u32 s61, s5, 10752
  buffer_load_dwordx4 v2, s[20:23], s61 offen lds
  s_cmp_lg_u32 s95, 16
  s_cbranch_scc1 L_h_t16
  buffer_load_dword v20, v3, s[36:39], s90 offen
  buffer_load_dword v20, v22, s[28:31], s91 offen
  buffer_load_dword v20, v22, s[32:35], s91 offen
L_h_t16:
  s_waitcnt vmcnt(8)
  s_add_u32 s92, s92, 1
  s_cmp_eq_u32 s92, 28
  s_cselect_b32 s92, 0, s92
  s_mul_i32 s5, s92, 14336
  s_add_u32 s5, s5, s94
  s_lshl_b32 s6, s92, 12
  s_add_u32 m0, s6, 0
  s_add_u32 s61, s5, 0
  buffer_load_dwordx4 v2, s[20:23], s61 offen lds
  s_add_u32 m0, s6, 1024
  s_add_u32 s61, s5, 3584
  buffer_load_dwordx4 v2, s[20:23], s61 offen lds
  s_add_u32 m0, s6, 2048
  s_add_u32 s61, s5, 7168
  buffer_load_dwordx4 v2, s[20:23], s61 offen lds
  s_add_u32 m0, s6, 3072
  s_add_u32 s61, s5, 10752
  buffer_load_dwordx4 v2, s[20:23], s61 offen lds
  s_cmp_lg_u32 s95, 17
  s_cbranch_scc1 L_h_t17
  buffer_load_dword v20, v3, s[36:39], s90 offen
  buffer_load_dword v20, v22, s[28:31], s91 offen
  buffer_load_dword v20, v22, s[32:35], s91 offen
L_h_t17:
  s_waitcnt vmcnt(8)
  s_add_u32 s92, s92, 1
  s_cmp_eq_u32 s92, 28
  s_cselect_b32 s92, 0, s92
  s_mul_i32 s5, s92, 14336
  s_add_u32 s5, s5, s94
  s_lshl_b32 s6, s92, 12
  s_add_u32 m0, s6, 0
  s_add_u32 s61, s5, 0
  buffer_load_dwordx4 v2, s[20:23], s61 offen lds
  s_add_u32 m0, s6, 1024
  s_add_u32 s61, s5, 3584
  buffer_load_dwordx4 v2, s[20:23], s61 offen lds
  s_add_u32 m0, s6, 2048
  s_add_u32 s61, s5, 7168
  buffer_load_dwordx4 v2, s[20:23], s61 offen lds
  s_add_u32 m0, s6, 3072
  s_add_u32 s61, s5, 10752
  buffer_load_dwordx4 v2, s[20:23], s61 offen lds
  s_cmp_lg_u32 s95, 18
  s_cbranch_scc1 L_h_t18
  buffer_load_dword v20, v3, s[36:39], s90 offen
  buffer_load_dword v20, v22, s[28:31], s91 offen
  buffer_load_dword v20, v22, s[32:35], s91 offen
L_h_t18:
  s_waitcnt vmcnt(8)
  s_add_u32 s92, s92, 1
  s_cmp_eq_u32 s92, 28
  s_cselect_b32 s92, 0, s92
  s_mul_i32 s5, s92, 14336
  s_add_u32 s5, s5, s94
  s_lshl_b32 s6, s92, 12
  s_add_u32 m0, s6, 0
  s_add_u32 s61, s5, 0
  buffer_load_dwordx4 v2, s[20:23], s61 offen lds
  s_add_u32 m0, s6, 1024
  s_add_u32 s61, s5, 3584
  buffer_load_dwordx4 v2, s[20:23], s61 offen lds
  s_add_u32 m0, s6, 2048
  s_add_u32 s61, s5, 7168
  buffer_load_dwordx4 v2, s[20:23], s61 offen lds
  s_add_u32 m0, s6, 3072
  s_add_u32 s61, s5, 10752
  buffer_load_dwordx4 v2, s[20:23], s61 offen lds
  s_cmp_lg_u32 s95, 19
  s_cbranch_scc1 L_h_t19
  buffer_load_dword v20, v3, s[36:39], s90 offen
  buffer_load_dword v20, v22, s[28:31], s91 offen
  buffer_load_dword v20, v22, s[32:35], s91 offen
L_h_t19:
  s_waitcnt vmcnt(8)
  s_add_u32 s92, s92, 1
  s_cmp_eq_u32 s92, 28
  s_cselect_b32 s92, 0, s92
  s_mul_i32 s5, s92, 14336
  s_add_u32 s5, s5, s94
  s_lshl_b32 s6, s92, 12
  s_add_u32 m0, s6, 0
  s_add_u32 s61, s5, 0
  buffer_load_dwordx4 v2, s[20:23], s61 offen lds
  s_add_u32 m0, s6, 1024
  s_add_u32 s61, s5, 3584
  buffer_load_dwordx4 v2, s[20:23], s61 offen lds
  s_add_u32 m0, s6, 2048
  s_add_u32 s61, s5, 7168
  buffer_load_dwordx4 v2, s[20:23], s61 offen lds
  s_add_u32 m0, s6, 3072
  s_add_u32 s61, s5, 10752
  buffer_load_dwordx4 v2, s[20:23], s61 offen lds
  s_cmp_lg_u32 s95, 20
  s_cbranch_scc1 L_h_t20
  buffer_load_dword v20, v3, s[36:39], s90 offen
  buffer_load_dword v20, v22, s[28:31], s91 offen
  buffer_load_dword v20, v22, s[32:35], s91 offen
L_h_t20:
  s_waitcnt vmcnt(8)
  s_add_u32 s92, s92, 1
  s_cmp_eq_u32 s92, 28
  s_cselect_b32 s92, 0, s92
  s_mul_i32 s5, s92, 14336
  s_add_u32 s5, s5, s94
  s_lshl_b32 s6, s92, 12
  s_add_u32 m0, s6, 0
  s_add_u32 s61, s5, 0
  buffer_load_dwordx4 v2, s[20:23], s61 offen lds
  s_add_u32 m0, s6, 1024
  s_add_u32 s61, s5, 3584
  buffer_load_dwordx4 v2, s[20:23], s61 offen lds
  s_add_u32 m0, s6, 2048
  s_add_u32 s61, s5, 7168
  buffer_load_dwordx4 v2, s[20:23], s61 offen lds
  s_add_u32 m0, s6, 3072
  s_add_u32 s61, s5, 10752
  buffer_load_dwordx4 v2, s[20:23], s61 offen lds
  s_cmp_lg_u32 s95, 21
  s_cbranch_scc1 L_h_t21
  buffer_load_dword v20, v3, s[36:39], s90 offen
  buffer_load_dword v20, v22, s[28:31], s91 offen
  buffer_load_dword v20, v22, s[32:35], s91 offen
L_h_t21:
  s_waitcnt vmcnt(8)
  s_add_u32 s92, s92, 1
  s_cmp_eq_u32 s92, 28
  s_cselect_b32 s92, 0, s92
  s_mul_i32 s5, s92, 14336
  s_add_u32 s5, s5, s94
  s_lshl_b32 s6, s92, 12
  s_add_u32 m0, s6, 0
  s_add_u32 s61, s5, 0
  buffer_load_dwordx4 v2, s[20:23], s61 offen lds
  s_add_u32 m0, s6, 1024
  s_add_u32 s61, s5, 3584
  buffer_load_dwordx4 v2, s[20:23], s61 offen lds
  s_add_u32 m0, s6, 2048
  s_add_u32 s61, s5, 7168
  buffer_load_dwordx4 v2, s[20:23], s61 offen lds
  s_add_u32 m0, s6, 3072
  s_add_u32 s61, s5, 10752
  buffer_load_dwordx4 v2, s[20:23], s61 offen lds
  s_cmp_lg_u32 s95, 22
  s_cbranch_scc1 L_h_t22
  buffer_load_dword v20, v3, s[36:39], s90 offen
  buffer_load_dword v20, v22, s[28:31], s91 offen
  buffer_load_dword v20, v22, s[32:35], s91 offen
L_h_t22:
  s_waitcnt vmcnt(8)
  s_add_u32 s92, s92, 1
  s_cmp_eq_u32 s92, 28
  s_cselect_b32 s92, 0, s92
  s_mul_i32 s5, s92, 14336
  s_add_u32 s5, s5, s94
  s_lshl_b32 s6, s92, 12
  s_add_u32 m0, s6, 0
  s_add_u32 s61, s5, 0
  buffer_load_dwordx4 v2, s[20:23], s61 offen lds
  s_add_u32 m0, s6, 1024
  s_add_u32 s61, s5, 3584
  buffer_load_dwordx4 v2, s[20:23], s61 offen lds
  s_add_u32 m0, s6, 2048
  s_add_u32 s61, s5, 7168
  buffer_load_dwordx4 v2, s[20:23], s61 offen lds
  s_add_u32 m0, s6, 3072
  s_add_u32 s61, s5, 10752
  buffer_load_dwordx4 v2, s[20:23], s61 offen lds
  s_cmp_lg_u32 s95, 23
  s_cbranch_scc1 L_h_t23
  buffer_load_dword v20, v3, s[36:39], s90 offen
  buffer_load_dword v20, v22, s[28:31], s91 offen
  buffer_load_dword v20, v22, s[32:35], s91 offen
L_h_t23:
  s_waitcnt vmcnt(8)
  s_add_u32 s92, s92, 1
  s_cmp_eq_u32 s92, 28
  s_cselect_b32 s92, 0, s92
  s_mul_i32 s5, s92, 14336
  s_add_u32 s5, s5, s94
  s_lshl_b32 s6, s92, 12
  s_add_u32 m0, s6, 0
  s_add_u32 s61, s5, 0
  buffer_load_dwordx4 v2, s[20:23], s61 offen lds
  s_add_u32 m0, s6, 1024
  s_add_u32 s61, s5, 3584
  buffer_load_dwordx4 v2, s[20:23], s61 offen lds
  s_add_u32 m0, s6, 2048
  s_add_u32 s61, s5, 7168
  buffer_load_dwordx4 v2, s[20:23], s61 offen lds
  s_add_u32 m0, s6, 3072
  s_add_u32 s61, s5, 10752
  buffer_load_dwordx4 v2, s[20:23], s61 offen lds
  s_cmp_lg_u32 s95, 24
  s_cbranch_scc1 L_h_t24
  buffer_load_dword v20, v3, s[36:39], s90 offen
  buffer_load_dword v20, v22, s[28:31], s91 offen
  buffer_load_dword v20, v22, s[32:35], s91 offen
L_h_t24:
  s_waitcnt vmcnt(8)
  s_add_u32 s92, s92, 1
  s_cmp_eq_u32 s92, 28
  s_cselect_b32 s92, 0, s92
  s_mul_i32 s5, s92, 14336
  s_add_u32 s5, s5, s94
  s_lshl_b32 s6, s92, 12
  s_add_u32 m0, s6, 0
  s_add_u32 s61, s5, 0
  buffer_load_dwordx4 v2, s[20:23], s61 offen lds
  s_add_u32 m0, s6, 1024
  s_add_u32 s61, s5, 3584
  buffer_load_dwordx4 v2, s[20:23], s61 offen lds
  s_add_u32 m0, s6, 2048
  s_add_u32 s61, s5, 7168
  buffer_load_dwordx4 v2, s[20:23], s61 offen lds
  s_add_u32 m0, s6, 3072
  s_add_u32 s61, s5, 10752
  buffer_load_dwordx4 v2, s[20:23], s61 offen lds
  s_cmp_lg_u32 s95, 25
  s_cbranch_scc1 L_h_t25
  buffer_load_dword v20, v3, s[36:39], s90 offen
  buffer_load_dword v20, v22, s[28:31], s91 offen
  buffer_load_dword v20, v22, s[32:35], s91 offen
L_h_t25:
  s_waitcnt vmcnt(8)
  s_add_u32 s92, s92, 1
  s_cmp_eq_u32 s92, 28
  s_cselect_b32 s92, 0, s92
  s_mul_i32 s5, s92, 14336
  s_add_u32 s5, s5, s94
  s_lshl_b32 s6, s92, 12
  s_add_u32 m0, s6, 0
  s_add_u32 s61, s5, 0
  buffer_load_dwordx4 v2, s[20:23], s61 offen lds
  s_add_u32 m0, s6, 1024
  s_add_u32 s61, s5, 3584
  buffer_load_dwordx4 v2, s[20:23], s61 offen lds
  s_add_u32 m0, s6, 2048
  s_add_u32 s61, s5, 7168
  buffer_load_dwordx4 v2, s[20:23], s61 offen lds
  s_add_u32 m0, s6, 3072
  s_add_u32 s61, s5, 10752
  buffer_load_dwordx4 v2, s[20:23], s61 offen lds
  s_cmp_lg_u32 s95, 26
  s_cbranch_scc1 L_h_t26
  buffer_load_dword v20, v3, s[36:39], s90 offen
  buffer_load_dword v20, v22, s[28:31], s91 offen
  buffer_load_dword v20, v22, s[32:35], s91 offen
L_h_t26:
  s_waitcnt vmcnt(8)
  s_add_u32 s92, s92, 1
  s_cmp_eq_u32 s92, 28
  s_cselect_b32 s92, 0, s92
  s_mul_i32 s5, s92, 14336
  s_add_u32 s5, s5, s94
  s_lshl_b32 s6, s92, 12
  s_add_u32 m0, s6, 0
  s_add_u32 s61, s5, 0
  buffer_load_dwordx4 v2, s[20:23], s61 offen lds
  s_add_u32 m0, s6, 1024
  s_add_u32 s61, s5, 3584
  buffer_load_dwordx4 v2, s[20:23], s61 offen lds
  s_add_u32 m0, s6, 2048
  s_add_u32 s61, s5, 7168
  buffer_load_dwordx4 v2, s[20:23], s61 offen lds
  s_add_u32 m0, s6, 3072
  s_add_u32 s61, s5, 10752
  buffer_load_dwordx4 v2, s[20:23], s61 offen lds
  s_cmp_lg_u32 s95, 27
  s_cbranch_scc1 L_h_t27
  buffer_load_dword v20, v3, s[36:39], s90 offen
  buffer_load_dword v20, v22, s[28:31], s91 offen
  buffer_load_dword v20, v22, s[32:35], s91 offen
L_h_t27:
  s_waitcnt vmcnt(8)
  s_add_u32 s92, s92, 1
  s_cmp_eq_u32 s92, 28
  s_cselect_b32 s92, 0, s92
  s_waitcnt vmcnt(0)
  s_cmp_lt_i32 s3, 0
  s_cbranch_scc1 L_h_end
  v_lshrrev_b32 v22, 2, v0
  v_mul_u32_u24 v22, 3584, v22
  v_and_b32 v23, 3, v0
  v_lshl_add_u32 v22, v23, 4, v22
  v_lshlrev_b32 v23, 12, v23
  v_add_u32 v23, 118276, v23
  s_lshl_b32 s90, s3, 6
  s_mul_i32 s91, s3, 28672
  s_add_u32 s63, s90, 0
  buffer_load_dwordx4 v[32:35], v22, s[28:31], s63 offen
  buffer_load_dwordx4 v[36:39], v22, s[32:35], s63 offen
  s_add_u32 s63, s90, 57344
  buffer_load_dwordx4 v[40:43], v22, s[28:31], s63 offen
  buffer_load_dwordx4 v[44:47], v22, s[32:35], s63 offen
  s_add_u32 s63, s90, 114688
  buffer_load_dwordx4 v[48:51], v22, s[28:31], s63 offen
  buffer_load_dwordx4 v[52:55], v22, s[32:35], s63 offen
  s_add_u32 s63, s90, 172032
  buffer_load_dwordx4 v[56:59], v22, s[28:31], s63 offen
  buffer_load_dwordx4 v[60:63], v22, s[32:35], s63 offen
  s_add_u32 s63, s90, 229376
  buffer_load_dwordx4 v[64:67], v22, s[28:31], s63 offen
  buffer_load_dwordx4 v[68:71], v22, s[32:35], s63 offen
  s_add_u32 s63, s90, 286720
  buffer_load_dwordx4 v[72:75], v22, s[28:31], s63 offen
  buffer_load_dwordx4 v[76:79], v22, s[32:35], s63 offen
  s_add_u32 s63, s90, 344064
  buffer_load_dwordx4 v[80:83], v22, s[28:31], s63 offen
  buffer_load_dwordx4 v[84:87], v22, s[32:35], s63 offen
  s_add_u32 s63, s90, 401408
  buffer_load_dwordx4 v[88:91], v22, s[28:31], s63 offen
  buffer_load_dwordx4 v[92:95], v22, s[32:35], s63 offen
  s_add_u32 s63, s90, 458752
  buffer_load_dwordx4 v[96:99], v22, s[28:31], s63 offen
  buffer_load_dwordx4 v[100:103], v22, s[32:35], s63 offen
  s_add_u32 s63, s90, 516096
  buffer_load_dwordx4 v[104:107], v22, s[28:31], s63 offen
  buffer_load_dwordx4 v[108:111], v22, s[32:35], s63 offen
  s_add_u32 s63, s90, 573440
  buffer_load_dwordx4 v[112:115], v22, s[28:31], s63 offen
  buffer_load_dwordx4 v[116:119], v22, s[32:35], s63 offen
  s_add_u32 s63, s90, 630784
  buffer_load_dwordx4 v[120:123], v22, s[28:31], s63 offen
  buffer_load_dwordx4 v[124:127], v22, s[32:35], s63 offen
  s_add_u32 s63, s90, 688128
  buffer_load_dwordx4 v[128:131], v22, s[28:31], s63 offen
  buffer_load_dwordx4 v[132:135], v22, s[32:35], s63 offen
  s_add_u32 s63, s90, 745472
  buffer_load_dwordx4 v[136:139], v22, s[28:31], s63 offen
  buffer_load_dwordx4 v[140:143], v22, s[32:35], s63 offen
  s_add_u32 s63, s90, 802816
  buffer_load_dwordx4 v[144:147], v22, s[28:31], s63 offen
  buffer_load_dwordx4 v[148:151], v22, s[32:35], s63 offen
  s_add_u32 s63, s90, 860160
  buffer_load_dwordx4 v[152:155], v22, s[28:31], s63 offen
  buffer_load_dwordx4 v[156:159], v22, s[32:35], s63 offen
  s_add_u32 s63, s90, 917504
  buffer_load_dwordx4 v[160:163], v22, s[28:31], s63 offen
  buffer_load_dwordx4 v[164:167], v22, s[32:35], s63 offen
  s_add_u32 s63, s90, 974848
  buffer_load_dwordx4 v[168:171], v22, s[28:31], s63 offen
  buffer_load_dwordx4 v[172:175], v22, s[32:35], s63 offen
  s_add_u32 s63, s90, 1032192
  buffer_load_dwordx4 v[176:179], v22, s[28:31], s63 offen
  buffer_load_dwordx4 v[180:183], v22, s[32:35], s63 offen
  s_add_u32 s63, s90, 1089536
  buffer_load_dwordx4 v[184:187], v22, s[28:31], s63 offen
  buffer_load_dwordx4 v[188:191], v22, s[32:35], s63 offen
  s_add_u32 s63, s90, 1146880
  buffer_load_dwordx4 v[192:195], v22, s[28:31], s63 offen
  buffer_load_dwordx4 v[196:199], v22, s[32:35], s63 offen
  s_add_u32 s63, s90, 1204224
  buffer_load_dwordx4 v[200:203], v22, s[28:31], s63 offen
  buffer_load_dwordx4 v[204:207], v22, s[32:35], s63 offen
  s_add_u32 s63, s90, 1261568
  buffer_load_dwordx4 v[208:211], v22, s[28:31], s63 offen
  buffer_load_dwordx4 v[212:215], v22, s[32:35], s63 offen
  s_add_u32 s63, s90, 1318912
  buffer_load_dwordx4 v[216:219], v22, s[28:31], s63 offen
  buffer_load_dwordx4 v[220:223], v22, s[32:35], s63 offen
  s_add_u32 s63, s90, 1376256
  buffer_load_dwordx4 v[224:227], v22, s[28:31], s63 offen
  buffer_load_dwordx4 v[228:231], v22, s[32:35], s63 offen
  s_add_u32 s63, s90, 1433600
  buffer_load_dwordx4 v[232:235], v22, s[28:31], s63 offen
  buffer_load_dwordx4 v[236:239], v22, s[32:35], s63 offen
  s_add_u32 s63, s90, 1490944
  buffer_load_dwordx4 v[240:243], v22, s[28:31], s63 offen
  buffer_load_dwordx4 v[244:247], v22, s[32:35], s63 offen
  s_add_u32 s63, s90, 1548288
  buffer_load_dwordx4 v[248:251], v22, s[28:31], s63 offen
  buffer_load_dwordx4 v[252:255], v22, s[32:35], s63 offen
L_h_comb:
  s_barrier
  ds_read_b32 v24, v23
  s_waitcnt lgkmcnt(0)
  v_cmp_ne_u32 vcc, 0, v24
  s_cbranch_vccz L_h_go
  s_cmp_lg_u32 s97, 0
  s_cbranch_scc1 L_h_go
  s_mov_b32 s97, 1
  s_barrier
  s_barrier
  s_barrier
  s_barrier
  s_branch L_h_comb
L_h_go:
  s_barrier
  s_barrier
  s_mov_b32 m0, 149504
  s_add_u32 s63, s91, 0
  buffer_load_dwordx4 v1, s[36:39], s63 offen offset:0 lds
  buffer_load_dwordx4 v1, s[36:39], s63 offen offset:1024 lds
  buffer_load_dwordx4 v1, s[36:39], s63 offen offset:2048 lds
  buffer_load_dwordx4 v1, s[36:39], s63 offen offset:3072 lds
  s_mov_b32 m0, 153600
  s_add_u32 s63, s91, 4096
  buffer_load_dwordx4 v1, s[36:39], s63 offen offset:0 lds
  buffer_load_dwordx4 v1, s[36:39], s63 offen offset:1024 lds
  buffer_load_dwordx4 v1, s[36:39], s63 offen offset:2048 lds
  buffer_load_dwordx4 v1, s[36:39], s63 offen offset:3072 lds
  s_mov_b32 m0, 157696
  s_add_u32 s63, s91, 8192
  buffer_load_dwordx4 v1, s[36:39], s63 offen offset:0 lds
  buffer_load_dwordx4 v1, s[36:39], s63 offen offset:1024 lds
  buffer_load_dwordx4 v1, s[36:39], s63 offen offset:2048 lds
  buffer_load_dwordx4 v1, s[36:39], s63 offen offset:3072 lds
  s_mov_b32 m0, 161792
  s_add_u32 s63, s91, 12288
  buffer_load_dwordx4 v1, s[36:39], s63 offen offset:0 lds
  buffer_load_dwordx4 v1, s[36:39], s63 offen offset:1024 lds
  s_waitcnt vmcnt(14)
  s_barrier
  s_mov_b32 m0, 57344
  s_add_u32 s63, s91, 14336
  buffer_load_dwordx4 v1, s[36:39], s63 offen offset:0 lds
  buffer_load_dwordx4 v1, s[36:39], s63 offen offset:1024 lds
  buffer_load_dwordx4 v1, s[36:39], s63 offen offset:2048 lds
  buffer_load_dwordx4 v1, s[36:39], s63 offen offset:3072 lds
  s_mov_b32 m0, 61440
  s_add_u32 s63, s91, 18432
  buffer_load_dwordx4 v1, s[36:39], s63 offen offset:0 lds
  buffer_load_dwordx4 v1, s[36:39], s63 offen offset:1024 lds
  buffer_load_dwordx4 v1, s[36:39], s63 offen offset:2048 lds
  buffer_load_dwordx4 v1, s[36:39], s63 offen offset:3072 lds
  s_mov_b32 m0, 65536
  s_add_u32 s63, s91, 22528
  buffer_load_dwordx4 v1, s[36:39], s63 offen offset:0 lds
  buffer_load_dwordx4 v1, s[36:39], s63 offen offset:1024 lds
  buffer_load_dwordx4 v1, s[36:39], s63 offen offset:2048 lds
  buffer_load_dwordx4 v1, s[36:39], s63 offen offset:3072 lds
  s_mov_b32 m0, 69632
  s_add_u32 s63, s91, 26624
  buffer_load_dwordx4 v1, s[36:39], s63 offen offset:0 lds
  buffer_load_dwordx4 v1, s[36:39], s63 offen offset:1024 lds
  ds_write_b128 v1, v[32:35] offset:0
  ds_write_b128 v1, v[36:39] offset:28672
  ds_write_b128 v1, v[40:43] offset:1024
  ds_write_b128 v1, v[44:47] offset:29696
  ds_write_b128 v1, v[48:51] offset:2048
  ds_write_b128 v1, v[52:55] offset:30720
  ds_write_b128 v1, v[56:59] offset:3072
  ds_write_b128 v1, v[60:63] offset:31744
  ds_write_b128 v1, v[64:67] offset:4096
  ds_write_b128 v1, v[68:71] offset:32768
  ds_write_b128 v1, v[72:75] offset:5120
  ds_write_b128 v1, v[76:79] offset:33792
  ds_write_b128 v1, v[80:83] offset:6144
  ds_write_b128 v1, v[84:87] offset:34816
  ds_write_b128 v1, v[88:91] offset:7168
  ds_write_b128 v1, v[92:95] offset:35840
  ds_write_b128 v1, v[96:99] offset:8192
  ds_write_b128 v1, v[100:103] offset:36864
  ds_write_b128 v1, v[104:107] offset:9216
  ds_write_b128 v1, v[108:111] offset:37888
  ds_write_b128 v1, v[112:115] offset:10240
  ds_write_b128 v1, v[116:119] offset:38912
  ds_write_b128 v1, v[120:123] offset:11264
  ds_write_b128 v1, v[124:127] offset:39936
  ds_write_b128 v1, v[128:131] offset:12288
  ds_write_b128 v1, v[132:135] offset:40960
  ds_write_b128 v1, v[136:139] offset:13312
  ds_write_b128 v1, v[140:143] offset:41984
  ds_write_b128 v1, v[144:147] offset:14336
  ds_write_b128 v1, v[148:151] offset:43008
  ds_write_b128 v1, v[152:155] offset:15360
  ds_write_b128 v1, v[156:159] offset:44032
  ds_write_b128 v1, v[160:163] offset:16384
  ds_write_b128 v1, v[164:167] offset:45056
  ds_write_b128 v1, v[168:171] offset:17408
  ds_write_b128 v1, v[172:175] offset:46080
  ds_write_b128 v1, v[176:179] offset:18432
  ds_write_b128 v1, v[180:183] offset:47104
  ds_write_b128 v1, v[184:187] offset:19456
  ds_write_b128 v1, v[188:191] offset:48128
  ds_write_b128 v1, v[192:195] offset:20480
  ds_write_b128 v1, v[196:199] offset:49152
  ds_write_b128 v1, v[200:203] offset:21504
  ds_write_b128 v1, v[204:207] offset:50176
  ds_write_b128 v1, v[208:211] offset:22528
  ds_write_b128 v1, v[212:215] offset:51200
  ds_write_b128 v1, v[216:219] offset:23552
  ds_write_b128 v1, v[220:223] offset:52224
  ds_write_b128 v1, v[224:227] offset:24576
  ds_write_b128 v1, v[228:231] offset:53248
  ds_write_b128 v1, v[232:235] offset:25600
  ds_write_b128 v1, v[236:239] offset:54272
  ds_write_b128 v1, v[240:243] offset:26624
  ds_write_b128 v1, v[244:247] offset:55296
  ds_write_b128 v1, v[248:251] offset:27648
  ds_write_b128 v1, v[252:255] offset:56320
  s_waitcnt lgkmcnt(0)
  s_waitcnt vmcnt(0)
L_h_end:
L_last:
  s_endpgm

.section .rodata,"a"
.p2align 6
.amdhsa_kernel sequential_preLN__mha_block__moe_arch_mod__prompt_kernel
  .amdhsa_next_free_vgpr 256
  .amdhsa_next_free_sgpr 102
  .amdhsa_accum_offset 256
  .amdhsa_group_segment_fixed_size 0
  .amdhsa_kernarg_size 88
  .amdhsa_user_sgpr_count 2
  .amdhsa_user_sgpr_kernarg_segment_ptr 1
  .amdhsa_system_sgpr_workgroup_id_x 1
  .amdhsa_float_denorm_mode_32 3
.end_amdhsa_kernel
```
